```python
import torch

def _softmax(x, axis=-1):
    return torch.softmax(x, dim=axis)
def _gelu(x):
    return torch.nn.functional.gelu(x, approximate="tanh")
def _silu(x):
    return torch.nn.functional.silu(x)
def _sigmoid(x):
    return torch.sigmoid(x)
def _layernorm(x, axis=-1, eps=1e-5):
    m = x.mean(dim=axis, keepdim=True)
    v = x.var(dim=axis, keepdim=True, unbiased=False)
    return (x - m) / torch.sqrt(v + eps)
def _scatter_add(tgt, idx, src, axis=0):
    return tgt.clone().index_add_(axis, idx, src)
def _segment_sum(src, seg, n):
    out = torch.zeros((n,) + src.shape[1:], dtype=src.dtype)
    return out.index_add_(0, seg, src)
def _pad(x, pw):
    flat = tuple(v for pair in reversed(pw) for v in pair)
    return torch.nn.functional.pad(x, flat)

kernel_name = 'interleave_layers__spectral_gfnet__spectral_gfnet__prompt'

def setup_inputs():

    _w = (lambda a: (lambda t: t.to(torch.bfloat16) if t.is_floating_point() else t)(torch.as_tensor(a)))
    def _A_setup():
        B, S, D = 1, 2048, 640
        Df = D // 2 + 1
        return {
            "x": _w((lambda *s: torch.randn(*s, dtype=torch.bfloat16) * 0.05)(B, S, D)),
            "w_r": _w((lambda *s: torch.randn(*s, dtype=torch.bfloat16) * 0.2)(S, Df) * 0.02),
            "w_i": _w((lambda *s: torch.randn(*s, dtype=torch.bfloat16) * 0.2)(S, Df) * 0.02),
        }
    _A_in = _A_setup()

    def _B_setup():
        B, S, D = 1, 2048, 640
        Df = D // 2 + 1
        return {
            "x": _w((lambda *s: torch.randn(*s, dtype=torch.bfloat16) * 0.05)(B, S, D)),
            "w_r": _w((lambda *s: torch.randn(*s, dtype=torch.bfloat16) * 0.2)(S, Df) * 0.02),
            "w_i": _w((lambda *s: torch.randn(*s, dtype=torch.bfloat16) * 0.2)(S, Df) * 0.02),
        }
    _B_in = _B_setup()

    return {
        "A_x": _A_in["x"],
        "A_w_r": _A_in["w_r"],
        "A_w_i": _A_in["w_i"],
        "B_x": _B_in["x"],
        "B_w_r": _B_in["w_r"],
        "B_w_i": _B_in["w_i"],
    }

def reference(A_x, A_w_r, A_w_i, B_x, B_w_r, B_w_i):
    def _A_ref(x, w_r, w_i):
        B, S, D = x.shape
        X = (lambda x, axes=(-2,-1): torch.fft.rfft2(x.float(), dim=axes))(x, axes=(-2, -1))
        W = w_r + 1j * w_i
        X = X * W
        y = (lambda x, s, axes=(-2,-1): torch.fft.irfft2(x, s=s, dim=axes).to(torch.bfloat16))(X, (S, D), axes=(-2, -1))
        return y

    def _B_ref(x, w_r, w_i):
        B, S, D = x.shape
        X = (lambda x, axes=(-2,-1): torch.fft.rfft2(x.float(), dim=axes))(x, axes=(-2, -1))
        W = w_r + 1j * w_i
        X = X * W
        y = (lambda x, s, axes=(-2,-1): torch.fft.irfft2(x, s=s, dim=axes).to(torch.bfloat16))(X, (S, D), axes=(-2, -1))
        return y

    x = A_x
    x = x + _A_ref(_layernorm(x, axis=-1), A_w_r, A_w_i)
    x = x + _B_ref(_layernorm(x, axis=-1), B_w_r, B_w_i)
    x = x + _A_ref(_layernorm(x, axis=-1), A_w_r, A_w_i)
    x = x + _B_ref(_layernorm(x, axis=-1), B_w_r, B_w_i)
    return x
```

```asm
; @launch grid=(256,1,1) block=(512,1,1) lds=80896
.amdgcn_target "amdgcn-amd-amdhsa--gfx950"
.text
.globl interleave_layers__spectral_gfnet__spectral_gfnet__prompt_kernel
.p2align 8
.type interleave_layers__spectral_gfnet__spectral_gfnet__prompt_kernel,@function
interleave_layers__spectral_gfnet__spectral_gfnet__prompt_kernel:
    s_load_dwordx2 s[4:5], s[0:1], 0
    s_load_dwordx2 s[12:13], s[0:1], 64
    s_cmp_ge_u32 s2, 256
    s_cbranch_scc1 L_end
    v_readfirstlane_b32 s36, v0
    s_cmp_lt_u32 s2, 16
    s_cbranch_scc1 L_prober
    s_getpc_b64 s[60:61]
    s_andn2_b32 s62, 0xf8, s2
    s_mul_i32 s62, s62, 96
    s_add_u32 s60, s60, s62
    s_addc_u32 s61, s61, 0
    v_mov_b32 v1, 0
    v_lshl_add_u64 v[2:3], v[0:1], 1, s[60:61]
    global_load_ubyte v1, v[2:3], off
    s_branch L_row
L_prober:
    s_cmp_ge_u32 s36, 0x1c0
    s_cbranch_scc1 L_probe
    s_barrier
L_row:
    s_add_u32 s2, s2, 160
    s_and_b32 s2, s2, 255
    v_and_b32 v4, 63, v0
    s_lshr_b32 s36, s36, 6
    s_bfe_u32 s60, s2, 0x30003
    s_lshl_b32 s60, s60, 1
    s_lshr_b32 s61, s36, 2
    s_or_b32 s62, s60, s61
    s_lshr_b32 s60, s2, 6
    s_lshl_b32 s60, s60, 2
    s_and_b32 s61, s36, 3
    s_or_b32 s60, s60, s61
    s_lshl_b32 s60, s60, 4
    s_or_b32 s60, s60, s62
    s_and_b32 s61, s2, 3
    s_bfe_u32 s37, s2, 0x10002
    s_lshl1_add_u32 s37, s61, s37
    s_lshl3_add_u32 s60, s60, s37
    s_mul_i32 s39, s60, 1280
    v_lshlrev_b32 v5, 2, v4
    s_mov_b32 s6, 2621440
    s_mov_b32 s7, 0x20000
    s_nop 0
    s_waitcnt lgkmcnt(0)
    s_load_dword s38, s[12:13], 0
    buffer_load_dword v12, v5, s[4:7], s39 offen offset:0 nt
    buffer_load_dword v13, v5, s[4:7], s39 offen offset:256 nt
    buffer_load_dword v14, v5, s[4:7], s39 offen offset:512 nt
    buffer_load_dword v15, v5, s[4:7], s39 offen offset:768 nt
    buffer_load_dword v16, v5, s[4:7], s39 offen offset:1024 nt
    s_load_dwordx2 s[16:17], s[0:1], 8
    s_load_dwordx2 s[20:21], s[0:1], 16
    s_load_dwordx2 s[24:25], s[0:1], 32
    s_load_dwordx2 s[28:29], s[0:1], 40
    s_load_dwordx2 s[8:9], s[0:1], 48
    s_load_dwordx2 s[32:33], s[0:1], 56
    s_mov_b32 m0, 0
    s_lshl_b32 s37, s37, 5
    s_lshr_b32 s60, s2, 3
    s_or_b32 s37, s37, s60
    s_lshr_b32 s60, s37, 7
    s_lshl_b32 s60, s60, 2
    s_and_b32 s61, s36, 3
    s_or_b32 s60, s60, s61
    s_lshl_b32 s60, s60, 3
    s_bfe_u32 s61, s37, 0x30004
    s_or_b32 s60, s60, s61
    s_lshl_b32 s60, s60, 1
    s_lshr_b32 s61, s36, 2
    s_or_b32 s60, s60, s61
    s_lshl_b32 s60, s60, 4
    s_and_b32 s61, s37, 15
    s_or_b32 s60, s60, s61
    s_mul_i32 s40, s60, 642
    s_and_b32 s40, s40, -4
    v_mul_u32_u24 v56, 12, v4
    s_mov_b32 s18, 1314816
    s_mov_b32 s19, 0x20000
    s_mov_b64 s[22:23], s[18:19]
    s_mov_b64 s[26:27], s[18:19]
    s_mov_b64 s[30:31], s[18:19]
    s_mov_b32 s14, 29360128
    s_mov_b32 s15, 0x20000
    v_and_b32 v28, 15, v4
    v_lshrrev_b32 v29, 4, v4
    v_lshrrev_b32 v30, 2, v28
    v_sub_u32 v30, v28, v30
    v_cvt_f32_u32 v7, v28
    v_cvt_f32_u32 v8, v29
    v_cvt_f32_u32 v17, v30
    v_lshlrev_b32_e64 v6, 4, v4
    v_add_u32 v6, 56320, v6
    s_cmp_ge_u32 s36, 6
    s_cbranch_scc1 L_c_done
    s_cmp_ge_u32 s36, 5
    s_cbranch_scc1 L_c_g8
    s_cmp_ge_u32 s36, 3
    s_cbranch_scc1 L_c_f
    s_cmp_ge_u32 s36, 1
    s_cbranch_scc1 L_c_tw
    v_mul_f32 v19, 0x3e4ccccd, v17
    v_mul_f32_e64 v18, v8, v19
    v_mul_f32 v18, 0x3e800000, v18
    v_mov_b32_e64 v32, v18
    v_fma_f32 v33, 1.0, v19, v18
    v_fma_f32 v34, 2.0, v19, v18
    v_fmamk_f32 v35, v19, 0x40400000, v18
    v_cos_f32 v28, v32
    v_cos_f32 v29, v33
    v_cos_f32 v30, v34
    v_cos_f32 v31, v35
    v_sin_f32 v32, v32
    v_sin_f32 v33, v33
    v_sin_f32 v34, v34
    v_sin_f32 v35, v35
    v_cvt_pk_f16_f32 v40, v28, v29
    v_cvt_pk_f16_f32 v44, -v32, -v33
    v_cvt_pk_f16_f32 v41, v30, v31
    v_cvt_pk_f16_f32 v45, -v34, -v35
    v_fma_f32 v32, 4.0, v19, v18
    v_cos_f32 v28, v32
    v_sin_f32 v32, v32
    v_cvt_pk_f16_f32 v42, v28, 0
    v_cvt_pk_f16_f32 v46, -v32, 0
    v_mov_b32 v43, 0
    v_mov_b32 v47, 0
    ds_write_b128 v6, v[40:43] offset:0
    ds_write_b128 v6, v[44:47] offset:1024
    s_branch L_c_done
L_c_tw:
    s_sub_u32 s60, s36, 1
    v_cvt_f32_u32_e64 v18, s60
    v_mul_f32 v19, 0x3acccccd, v17
    v_fmamk_f32 v18, v8, 0x41000000, v18
    v_mul_f32 v18, v18, v19
    v_add_f32 v19, v19, v19
    v_mov_b32_e64 v32, v18
    v_fma_f32 v33, 1.0, v19, v18
    v_fma_f32 v34, 2.0, v19, v18
    v_fmamk_f32 v35, v19, 0x40400000, v18
    v_cos_f32 v28, v32
    v_cos_f32 v29, v33
    v_cos_f32 v30, v34
    v_cos_f32 v31, v35
    v_sin_f32 v32, v32
    v_sin_f32 v33, v33
    v_sin_f32 v34, v34
    v_sin_f32 v35, v35
    v_mul_f32 v28, 0x3d000000, v28
    v_mul_f32 v32, 0x3d000000, v32
    v_cvt_pk_f16_f32 v40, v28, v32
    v_mul_f32 v29, 0x3d000000, v29
    v_mul_f32 v33, 0x3d000000, v33
    v_cvt_pk_f16_f32 v41, v29, v33
    v_mul_f32 v30, 0x3d000000, v30
    v_mul_f32 v34, 0x3d000000, v34
    v_cvt_pk_f16_f32 v42, v30, v34
    v_mul_f32 v31, 0x3d000000, v31
    v_mul_f32 v35, 0x3d000000, v35
    v_cvt_pk_f16_f32 v43, v31, v35
    s_mul_i32 s60, s36, 1024
    v_add_u32_e64 v28, s60, v6
    ds_write_b128 v28, v[40:43] offset:1024
    s_branch L_c_done
L_c_f:
    s_sub_u32 s60, s36, 3
    v_cvt_f32_u32_e64 v18, s60
    v_mul_f32 v19, 0x3d000000, v7
    v_fmamk_f32 v18, v8, 0x41000000, v18
    v_mul_f32 v18, v18, v19
    v_add_f32 v19, v19, v19
    v_mov_b32_e64 v32, v18
    v_fma_f32 v33, 1.0, v19, v18
    v_fma_f32 v34, 2.0, v19, v18
    v_fmamk_f32 v35, v19, 0x40400000, v18
    v_cos_f32 v28, v32
    v_cos_f32 v29, v33
    v_cos_f32 v30, v34
    v_cos_f32 v31, v35
    v_sin_f32 v32, v32
    v_sin_f32 v33, v33
    v_sin_f32 v34, v34
    v_sin_f32 v35, v35
    v_cvt_pk_f16_f32 v40, v28, v32
    v_cvt_pk_f16_f32 v44, -v32, v28
    v_cvt_pk_f16_f32 v41, v29, v33
    v_cvt_pk_f16_f32 v45, -v33, v29
    v_cvt_pk_f16_f32 v42, v30, v34
    v_cvt_pk_f16_f32 v46, -v34, v30
    v_cvt_pk_f16_f32 v43, v31, v35
    v_cvt_pk_f16_f32 v47, -v35, v31
    s_mul_i32 s60, s36, 2048
    v_add_u32_e64 v28, s60, v6
    ds_write_b128 v28, v[40:43] offset:0
    ds_write_b128 v28, v[44:47] offset:1024
    s_branch L_c_done
L_c_g8:
    v_bfe_u32 v28, v4, 3, 1
    v_and_b32 v29, 3, v4
    v_lshl_add_u32 v28, v28, 2, v29
    v_cvt_f32_u32 v19, v28
    v_lshrrev_b32 v28, 5, v4
    v_cvt_f32_u32_e64 v18, v28
    v_mul_f32 v19, 0x3e000000, v19
    v_mul_f32 v18, v18, v19
    v_mul_f32 v18, 4.0, v18
    v_lshrrev_b32 v28, 2, v4
    v_xor_b32 v28, v28, v4
    v_bfe_u32 v28, v28, 2, 1
    v_add_u32 v17, -1, v28
    v_mov_b32 v32, v18
    v_fma_f32 v33, 1.0, v19, v18
    v_fma_f32 v34, 2.0, v19, v18
    v_fmamk_f32 v35, v19, 0x40400000, v18
    v_cos_f32 v28, v32
    v_cos_f32 v29, v33
    v_cos_f32 v30, v34
    v_cos_f32 v31, v35
    v_sin_f32 v32, v32
    v_sin_f32 v33, v33
    v_sin_f32 v34, v34
    v_sin_f32 v35, v35
    v_cvt_pk_f16_f32 v40, v28, v32
    v_cvt_pk_f16_f32 v44, -v32, v28
    v_cvt_pk_f16_f32 v41, v29, v33
    v_cvt_pk_f16_f32 v45, -v33, v29
    v_cvt_pk_f16_f32 v42, v30, v34
    v_cvt_pk_f16_f32 v46, -v34, v30
    v_cvt_pk_f16_f32 v43, v31, v35
    v_cvt_pk_f16_f32 v47, -v35, v31
    v_and_b32 v40, v17, v40
    v_and_b32 v41, v17, v41
    v_and_b32 v42, v17, v42
    v_and_b32 v43, v17, v43
    v_and_b32 v44, v17, v44
    v_and_b32 v45, v17, v45
    v_and_b32 v46, v17, v46
    v_and_b32 v47, v17, v47
    ds_write_b128 v6, v[40:43] offset:4096
    ds_write_b128 v6, v[44:47] offset:5120
L_c_done:
    s_nop 0
    s_waitcnt lgkmcnt(0)
    s_mov_b32 exec_hi, 0x3fffff
    buffer_load_dwordx3 v[60:62], v56, s[16:19], s40 offen nt
    buffer_load_dwordx3 v[64:66], v56, s[20:23], s40 offen nt
    s_barrier
    buffer_load_dwordx3 v[68:70], v56, s[24:27], s40 offen nt
    buffer_load_dwordx3 v[72:74], v56, s[28:31], s40 offen nt
    s_mov_b32 exec_hi, -1
    ds_read_b128 v[104:107], v6 offset:0
    ds_read_b128 v[108:111], v6 offset:1024
    ds_read_b128 v[112:115], v6 offset:2048
    ds_read_b128 v[116:119], v6 offset:3072
    ds_read_b128 v[20:23], v6 offset:6144
    ds_read_b128 v[24:27], v6 offset:7168
    ds_read_b128 v[120:123], v6 offset:8192
    ds_read_b128 v[124:127], v6 offset:9216
    s_nop 0
    s_mov_b64 s[10:11], s[6:7]
    s_mov_b32 s34, 256
    s_mov_b32 s35, 0x20000
    s_mov_b32 s42, 0x8000
    s_mov_b32 s44, 0x00010001
    s_mov_b32 s45, 0x40004000
    s_mov_b32 s46, 0x05040100
    s_mov_b32 s47, 0x07060302
    s_mov_b32 s48, 0x80008000
    s_mov_b32 s49, 0x7fff7fff
    s_and_b32 s60, s37, 128
    s_add_u32 s60, s60, s37
    s_lshl_b32 s65, s60, 6
    s_add_u32 s38, s38, 1
    s_and_b32 s60, s38, 15
    s_bfe_u32 s61, s38, 0x30004
    s_lshl_b32 s61, s61, 16
    s_or_b32 s60, s60, s61
    s_mul_i32 s64, s60, 0x1111
    s_xor_b32 s64, s64, 0x3210
    v_mov_b32 v36, -1
    v_mov_b32 v37, -1
    v_mov_b32 v38, -1
    v_mov_b32 v39, -1
    s_bfe_u32 s60, s37, 0x20005
    s_lshl_b32 s60, s60, 1
    s_bfe_u32 s61, s37, 0x10003
    s_or_b32 s60, s60, s61
    s_lshl_b32 s60, s60, 1
    s_lshr_b32 s61, s37, 7
    s_or_b32 s60, s60, s61
    s_lshl_b32 s60, s60, 3
    s_and_b32 s61, s37, 7
    s_or_b32 s60, s60, s61
    s_lshl_b32 s60, s60, 1
    s_bfe_u32 s61, s37, 0x10004
    s_or_b32 s60, s60, s61
    s_and_b32 s61, s60, 128
    s_add_u32 s60, s60, s61
    s_lshl_b32 s66, s60, 6
    v_lshlrev_b32_e64 v11, 4, v0
    s_mul_i32 s63, s36, 1536
    s_lshr_b32 s61, s36, 2
    s_lshl_b32 s61, s61, 6
    s_add_u32 s63, s63, s61
    v_lshl_add_u32 v59, v56, 1, s63
    v_and_b32 v28, 15, v4
    v_lshrrev_b32_e64 v29, 4, v4
    v_mul_u32_u24 v28, 80, v28
    v_mad_u32_u24 v28, v29, 12, v28
    s_add_u32 s63, s63, 16384
    v_add_u32_e64 v102, s63, v28
    s_add_u32 s63, s63, 1272
    v_sub_u32_e64 v103, s63, v28
    v_bfe_u32 v28, v4, 1, 1
    v_mul_u32_u24 v28, 6208, v28
    v_lshrrev_b32 v29, 2, v4
    v_and_b32 v30, 1, v4
    v_lshl_add_u32 v31, v29, 1, v30
    v_lshl_add_u32 v31, v31, 2, v28
    s_mul_i32 s60, s36, 160
    s_add_u32 s60, s60, 16388
    v_add_u32_e64 v9, s60, v31
    v_add_u32 v10, 128, v9
    s_and_b32 s60, s37, 1
    s_lshl_b32 s60, s60, 2
    s_add_u32 s60, s60, 12544
    v_add_u32 v168, s60, v9
    v_add_u32 v169, s60, v10
    v_and_b32_e64 v32, 12, v5
    v_lshrrev_b32 v136, v32, s64
    s_mul_i32 s60, s36, 20
    s_movk_i32 s61, 0x2000
    v_add_u32 v29, s60, v29
    v_and_b32 v63, 7, v29
    v_and_b32 v28, 3, v29
    v_lshrrev_b32 v29, 3, v29
    v_lshl_add_u32 v28, v29, 2, v28
    v_lshlrev_b32_e64 v32, 2, v32
    v_lshl_add_u32 v128, v28, 15, v32
    v_add_u32 v129, 262144, v128
    s_movk_i32 s60, 24448
    v_mul_u32_u24 v30, 5760, v28
    v_lshlrev_b32 v28, 7, v28
    v_add_u32 v31, 46080, v30
    v_add_u32 v29, 1024, v28
    v_and_or_b32 v128, v30, s60, v128
    v_and_or_b32 v129, v31, s60, v129
    v_and_or_b32 v128, v28, s61, v128
    v_and_or_b32 v129, v29, s61, v129
    v_lshlrev_b32 v140, 14, v136
    v_and_b32 v140, s45, v140
    v_lshlrev_b32 v141, 13, v136
    v_and_b32 v141, s45, v141
    v_lshlrev_b32 v142, 12, v136
    v_and_b32 v142, s45, v142
    v_lshlrev_b32 v143, 11, v136
    v_and_b32 v143, s45, v143
    v_lshrrev_b32 v136, 14, v140
    v_lshrrev_b32 v137, 14, v141
    v_lshrrev_b32 v138, 14, v142
    v_lshrrev_b32 v139, 14, v143
    s_add_u32 s60, s65, 393216
    v_bfe_u32 v28, v4, 3, 2
    v_lshrrev_b32_e64 v29, 5, v4
    v_lshl_add_u32 v28, v28, 2, v29
    v_and_b32_e64 v29, 7, v4
    v_lshl_add_u32 v29, v29, 3, s60
    v_lshl_add_u32 v132, v28, 13, v29
    v_lshrrev_b32_e64 v133, 1, v32
    v_lshrrev_b32 v134, v32, s64
    v_lshrrev_b32_e64 v135, 8, v134
    s_sub_u32 s60, s2, 160
    s_cmp_lt_u32 s60, 16
    s_cbranch_scc1 L_nopre
    v_cvt_f32_u32_e64 v17, s36
    v_fmamk_f32 v18, v8, 0x42000000, v17
    v_mul_f32 v19, 0x3a000000, v7
    v_mul_f32_e64 v18, v18, v19
    v_mul_f32 v19, 0x41000000, v19
    v_mov_b32_e64 v32, v18
    v_fma_f32 v33, 1.0, v19, v18
    v_fma_f32 v34, 2.0, v19, v18
    v_fmamk_f32 v35, v19, 0x40400000, v18
    v_cos_f32 v28, v32
    v_cos_f32 v29, v33
    v_cos_f32 v30, v34
    v_cos_f32 v31, v35
    v_sin_f32 v32, v32
    v_sin_f32 v33, v33
    v_sin_f32 v34, v34
    v_sin_f32 v35, v35
    v_cvt_pk_f16_f32 v80, v28, v32
    v_cvt_pk_f16_f32 v81, v29, v33
    v_cvt_pk_f16_f32 v82, v30, v34
    v_cvt_pk_f16_f32 v83, v31, v35
    ds_write_b128 v11, v[80:83] offset:0
    s_nop 0
    s_movk_i32 s60, 0x2c00
    v_pk_mul_f16 v76, v80, s60 op_sel_hi:[1,0]
    v_pk_mul_f16 v77, v81, s60 op_sel_hi:[1,0]
    v_pk_mul_f16 v78, v82, s60 op_sel_hi:[1,0]
    v_pk_mul_f16 v79, v83, s60 op_sel_hi:[1,0]
    v_mul_f32 v18, 0x41800000, v18
    v_mul_f32 v19, 0x41800000, v19
    v_mov_b32_e64 v32, v18
    v_fma_f32 v33, 1.0, v19, v18
    v_fma_f32 v34, 2.0, v19, v18
    v_fmamk_f32 v35, v19, 0x40400000, v18
    v_cos_f32 v28, v32
    v_cos_f32 v29, v33
    v_cos_f32 v30, v34
    v_cos_f32 v31, v35
    v_sin_f32 v32, v32
    v_sin_f32 v33, v33
    v_sin_f32 v34, v34
    v_sin_f32 v35, v35
    v_cvt_pk_f16_f32 v84, v28, v32
    v_cvt_pk_f16_f32 v88, -v32, v28
    v_cvt_pk_f16_f32 v85, v29, v33
    v_cvt_pk_f16_f32 v89, -v33, v29
    v_cvt_pk_f16_f32 v86, v30, v34
    v_cvt_pk_f16_f32 v90, -v34, v30
    v_cvt_pk_f16_f32 v87, v31, v35
    v_cvt_pk_f16_f32 v91, -v35, v31
    ds_write_b128 v11, v[84:87] offset:8192
L_nopre:
    s_mov_b32 s62, 0x3f803f80
    v_mov_b32 v183, 0
    v_mov_b32 v187, 0
    v_mov_b32 v31, 0x3acccccd
    s_mov_b64 exec, 3
    ds_write_b32 v5, v183 offset:56064
    s_mov_b64 exec, -1
    s_waitcnt vmcnt(4)
    s_cmp_lg_u32 s36, 0
    s_nop 0
    s_cbranch_scc1 L_nosigclr
    buffer_store_dwordx2 v[36:37], v132, s[12:15], 0 offen sc1
L_nosigclr:
    v_dot2_f32_bf16 v67, v12, s62, 0
    v_dot2_f32_bf16 v71, v12, v12, 0
    v_dot2_f32_bf16 v67, v13, s62, v67
    v_dot2_f32_bf16 v71, v13, v13, v71
    v_dot2_f32_bf16 v67, v14, s62, v67
    v_dot2_f32_bf16 v71, v14, v14, v71
    v_dot2_f32_bf16 v67, v15, s62, v67
    v_dot2_f32_bf16 v71, v15, v15, v71
    v_dot2_f32_bf16 v67, v16, s62, v67
    v_dot2_f32_bf16 v71, v16, v16, v71
    s_nop 2
    v_permlane32_swap_b32 v67, v71
    v_add_f32 v67, v67, v71
    v_lshlrev_b32 v170, 16, v12
    v_and_b32 v171, 0xffff0000, v12
    v_add_f32_dpp v67, v67, v67 row_ror:8 row_mask:0xf bank_mask:0xf
    v_lshlrev_b32_e64 v172, 16, v13
    v_and_b32 v173, 0xffff0000, v13
    v_add_f32_dpp v67, v67, v67 row_ror:4 row_mask:0xf bank_mask:0xf
    v_lshlrev_b32_e64 v174, 16, v14
    v_and_b32 v175, 0xffff0000, v14
    v_add_f32_dpp v67, v67, v67 row_ror:2 row_mask:0xf bank_mask:0xf
    v_lshlrev_b32_e64 v176, 16, v15
    v_and_b32 v177, 0xffff0000, v15
    v_add_f32_dpp v67, v67, v67 row_ror:1 row_mask:0xf bank_mask:0xf
    v_lshlrev_b32_e64 v178, 16, v16
    v_and_b32 v179, 0xffff0000, v16
    v_add_f32_dpp v67, v67, v67 row_bcast:15 row_mask:0xa bank_mask:0xf
    s_nop 0
    v_readlane_b32 s3, v67, 16
    v_readlane_b32 s41, v67, 48
    s_nop 0
    v_mul_f32 v28, s3, v31
    v_mul_f32 v29, v28, v28
    v_fma_f32 v29, s41, v31, -v29
    v_max_f32_e64 v29, 0, v29
    v_add_f32 v29, 0x3727c5ac, v29
    v_rsq_f32 v30, v29
    s_nop 0
    v_mul_f32_e64 v28, v28, v30
    v_pk_fma_f32 v[170:171], v[170:171], v[30:31], v[28:29] op_sel_hi:[1,0,0] neg_lo:[0,0,1] neg_hi:[0,0,1]
    v_pk_fma_f32 v[172:173], v[172:173], v[30:31], v[28:29] op_sel_hi:[1,0,0] neg_lo:[0,0,1] neg_hi:[0,0,1]
    v_pk_fma_f32 v[174:175], v[174:175], v[30:31], v[28:29] op_sel_hi:[1,0,0] neg_lo:[0,0,1] neg_hi:[0,0,1]
    v_pk_fma_f32 v[176:177], v[176:177], v[30:31], v[28:29] op_sel_hi:[1,0,0] neg_lo:[0,0,1] neg_hi:[0,0,1]
    v_pk_fma_f32 v[178:179], v[178:179], v[30:31], v[28:29] op_sel_hi:[1,0,0] neg_lo:[0,0,1] neg_hi:[0,0,1]
    v_cvt_pk_f16_f32 v180, v170, v172
    v_cvt_pk_f16_f32 v181, v174, v176
    v_cvt_pk_f16_f32 v182, v178, 0
    v_mul_f32 v29, v29, v30
    s_waitcnt lgkmcnt(0)
    s_load_dword s67, s[32:33], 128
    v_mfma_f32_16x16x32_f16 v[40:43], v[180:183], v[104:107], 0
    v_mfma_f32_16x16x32_f16 v[44:47], v[180:183], v[108:111], 0
    v_cvt_pk_f16_f32 v184, v171, v173
    v_cvt_pk_f16_f32 v185, v175, v177
    v_cvt_pk_f16_f32 v186, v179, 0
    s_nop 1
    v_mfma_f32_16x16x32_f16 v[48:51], v[184:187], v[104:107], 0
    v_mfma_f32_16x16x32_f16 v[52:55], v[184:187], v[108:111], 0
    s_lshl_b64 exec, 1, s36
    ds_write_b32 v5, v29 offset:56080
    s_nop 0
    s_mov_b64 exec, -1
    v_cvt_pk_f16_f32 v170, v40, v44
    v_cvt_pk_f16_f32 v171, v41, v45
    v_cvt_pk_f16_f32 v172, v42, v46
    v_cvt_pk_f16_f32 v173, v43, v47
    v_pk_mul_f16 v174, v170, v112 op_sel:[0,0] op_sel_hi:[1,0]
    v_pk_mul_f16 v175, v171, v113 op_sel:[0,0] op_sel_hi:[1,0]
    v_pk_mul_f16 v176, v172, v114 op_sel:[0,0] op_sel_hi:[1,0]
    v_pk_mul_f16 v177, v173, v115 op_sel:[0,0] op_sel_hi:[1,0]
    v_pk_fma_f16 v180, v170, v112, v174 op_sel:[1,1,0] op_sel_hi:[0,1,1] neg_hi:[1,0,0]
    v_pk_fma_f16 v181, v171, v113, v175 op_sel:[1,1,0] op_sel_hi:[0,1,1] neg_hi:[1,0,0]
    v_pk_fma_f16 v182, v172, v114, v176 op_sel:[1,1,0] op_sel_hi:[0,1,1] neg_hi:[1,0,0]
    v_pk_fma_f16 v183, v173, v115, v177 op_sel:[1,1,0] op_sel_hi:[0,1,1] neg_hi:[1,0,0]
    s_nop 0
    s_nop 0
    v_mfma_f32_16x16x32_f16 v[40:43], v[180:183], v[20:23], 0
    v_mfma_f32_16x16x32_f16 v[44:47], v[180:183], v[24:27], 0
    v_cvt_pk_f16_f32 v170, v48, v52
    v_cvt_pk_f16_f32 v171, v49, v53
    v_cvt_pk_f16_f32 v172, v50, v54
    v_cvt_pk_f16_f32 v173, v51, v55
    v_pk_mul_f16 v174, v170, v116 op_sel:[0,0] op_sel_hi:[1,0]
    v_pk_mul_f16 v175, v171, v117 op_sel:[0,0] op_sel_hi:[1,0]
    v_pk_mul_f16 v176, v172, v118 op_sel:[0,0] op_sel_hi:[1,0]
    v_pk_mul_f16 v177, v173, v119 op_sel:[0,0] op_sel_hi:[1,0]
    v_pk_fma_f16 v184, v170, v116, v174 op_sel:[1,1,0] op_sel_hi:[0,1,1] neg_hi:[1,0,0]
    v_pk_fma_f16 v185, v171, v117, v175 op_sel:[1,1,0] op_sel_hi:[0,1,1] neg_hi:[1,0,0]
    v_pk_fma_f16 v186, v172, v118, v176 op_sel:[1,1,0] op_sel_hi:[0,1,1] neg_hi:[1,0,0]
    v_pk_fma_f16 v187, v173, v119, v177 op_sel:[1,1,0] op_sel_hi:[0,1,1] neg_hi:[1,0,0]
    s_nop 0
    s_nop 0
    v_mfma_f32_16x16x32_f16 v[48:51], v[184:187], v[120:123], 0
    v_mfma_f32_16x16x32_f16 v[52:55], v[184:187], v[124:127], 0
    v_cvt_pk_f16_f32 v170, v40, v44
    v_cvt_pk_f16_f32 v171, v41, v45
    v_cvt_pk_f16_f32 v172, v42, v46
    s_nop 3
    s_nop 0
    v_cvt_pk_f16_f32 v174, v48, v52
    v_cvt_pk_f16_f32 v175, v49, v53
    v_cvt_pk_f16_f32 v176, v50, v54
    v_pk_add_f16 v180, v170, v174
    v_pk_add_f16 v181, v171, v175
    v_pk_add_f16 v182, v172, v176
    ds_write2_b32 v102, v180, v181 offset0:0 offset1:1
    ds_write_b32 v102, v182 offset:8
    v_pk_add_f16 v184, v170, v174 neg_lo:[0,1] neg_hi:[1,0]
    v_pk_add_f16 v185, v171, v175 neg_lo:[0,1] neg_hi:[1,0]
    v_pk_add_f16 v186, v172, v176 neg_lo:[0,1] neg_hi:[1,0]
    ds_write2_b32 v103, v184, v185 offset0:2 offset1:1
    ds_write_b32 v103, v186
    s_nop 0
    s_waitcnt vmcnt(2)
    v_perm_b32 v144, v64, v60, s46
    v_perm_b32 v145, v64, v60, s47
    v_perm_b32 v146, v65, v61, s46
    v_perm_b32 v147, v65, v61, s47
    v_perm_b32 v148, v66, v62, s46
    v_perm_b32 v149, v66, v62, s47
    s_mov_b32 exec_hi, 0x3fffff
    ds_write_b64 v59, v[144:145] offset:28928
    ds_write_b64 v59, v[146:147] offset:28936
    ds_write_b64 v59, v[148:149] offset:28944
    s_mov_b32 exec_hi, -1
    s_waitcnt lgkmcnt(0)
L_dtop_1:
    s_and_b32 s60, s67, 31
    s_cmp_lg_u32 s60, 16
    s_cbranch_scc1 L_retry_3
L_dok_2:
    s_waitcnt vmcnt(0)
    s_nop 0
    s_barrier
    ds_read_b64 v[30:31], v133 offset:56080
    ds_read2st64_b32 v[152:153], v9 offset0:0 offset1:6
    ds_read2st64_b32 v[154:155], v9 offset0:12 offset1:18
    ds_read2st64_b32 v[156:157], v10 offset0:0 offset1:6
    ds_read2st64_b32 v[158:159], v10 offset0:12 offset1:18
    ds_read2st64_b32 v[160:161], v168 offset0:0 offset1:6
    ds_read2st64_b32 v[162:163], v168 offset0:12 offset1:18
    ds_read2st64_b32 v[164:165], v169 offset0:0 offset1:6
    ds_read2st64_b32 v[166:167], v169 offset0:12 offset1:18
    s_bfe_u32 s60, s67, 0x40008
    s_bfe_u32 s61, s67, 0x4000c
    s_cmp_gt_u32 s61, s60
    s_cselect_b32 s60, 0xff, 0
    s_cselect_b32 s77, 24, 16
    s_lshr_b32 s77, s67, s77
    s_lshr_b32 s69, s67, 16
    s_bfe_u32 s63, s67, 0x30005
    s_lshr_b32 s61, 0xf0f0, s63
    s_xor_b32 s67, s60, s61
    s_mov_b32 s71, 16777216
    v_bfe_u32 v28, s67, v63, 1
    v_lshlrev_b32 v28, 13, v28
    v_bitop3_b32 v130, v128, v28, s66 bitop3:0x96
    v_bitop3_b32 v131, v129, v28, s66 bitop3:0x96
    v_bitop3_b32 v128, v128, v28, s65 bitop3:0x96
    v_bitop3_b32 v129, v129, v28, s65 bitop3:0x96
    s_cmp_lg_u32 s36, 0
    s_cbranch_scc1 L_nosig
    s_movk_i32 s61, 0xff
    s_waitcnt vmcnt(0) lgkmcnt(8)
    v_bfi_b32 v30, s61, v134, v30
    v_bfi_b32 v31, s61, v135, v31
    buffer_store_dwordx2 v[30:31], v132, s[12:15], 0 offen sc1
L_nosig:
    s_nop 0
    s_waitcnt lgkmcnt(6)
    v_bfi_b32 v152, s44, v136, v152
    v_bfi_b32 v153, s44, v137, v153
    v_bfi_b32 v154, s44, v138, v154
    v_bfi_b32 v155, s44, v139, v155
    buffer_store_dwordx4 v[152:155], v128, s[12:15], s71 offen sc1
    s_mov_b64 exec, 0xffff
    s_nop 0
    s_waitcnt lgkmcnt(4)
    v_bfi_b32 v156, s44, v136, v156
    v_bfi_b32 v157, s44, v137, v157
    v_bfi_b32 v158, s44, v138, v158
    v_bfi_b32 v159, s44, v139, v159
    buffer_store_dwordx4 v[156:159], v129, s[12:15], s71 offen sc1
    s_mov_b64 exec, -1
    s_and_b32 s68, s2, 7
    s_lshr_b32 s68, s67, s68
    s_and_b32 s68, s68, 1
    s_lshl_b32 s68, s68, 13
    s_waitcnt lgkmcnt(0)
    v_or3_b32 v144, v160, v161, v162
    s_mov_b64 exec, 0xffff
    v_or3_b32 v144, v164, v165, v144
    v_or3_b32 v144, v166, v167, v144
    s_mov_b64 exec, -1
    v_bitop3_b32 v144, v144, v163, s45 bitop3:0xa8
    v_cmp_ne_u32 vcc, 0, v144
    s_nop 0
    s_cmp_eq_u64 vcc, 0
    s_nop 0
    s_cselect_b32 s61, 0, s45
    v_bitop3_b32 v160, v160, v140, s61 bitop3:0x76
    v_bitop3_b32 v161, v161, v141, s61 bitop3:0x76
    v_bitop3_b32 v162, v162, v142, s61 bitop3:0x76
    v_bitop3_b32 v163, v163, v143, s61 bitop3:0x76
    v_bitop3_b32 v164, v164, v140, s61 bitop3:0x76
    v_bitop3_b32 v165, v165, v141, s61 bitop3:0x76
    v_bitop3_b32 v166, v166, v142, s61 bitop3:0x76
    v_bitop3_b32 v167, v167, v143, s61 bitop3:0x76
    s_mov_b32 s71, 20971520
    buffer_store_dwordx4 v[160:163], v130, s[12:15], s71 offen sc1
    s_mov_b64 exec, 0xffff
    buffer_store_dwordx4 v[164:167], v131, s[12:15], s71 offen sc1
    s_mov_b64 exec, -1
    s_lshr_b32 s60, s69, 4
    s_and_b32 s60, s60, 0xf0f
    s_and_b32 s61, s69, 0xf0f
    s_add_u32 s60, s60, s61
    s_lshr_b32 s61, s60, 8
    s_add_u32 s60, s60, s61
    s_and_b32 s61, s60, 0xff
    s_and_b32 s60, s77, 15
    s_lshl1_add_u32 s60, s60, 2
    s_cmp_gt_u32 s61, s60
    s_cselect_b32 s77, 1, 0
    s_xor_b32 s77, s77, s63
    s_and_b32 s77, s77, 1
    s_cmp_ge_u32 s2, 160
    s_cbranch_scc1 L_noncolumn
    s_lshr_b32 s60, s2, 3
    s_lshl_b32 s60, s60, 2
    s_and_b32 s61, s2, 3
    s_or_b32 s60, s60, s61
    s_lshl_b32 s61, s60, 15
    s_and_b32 s62, s2, 128
    s_lshl_b32 s62, s62, 6
    s_xor_b32 s62, s62, s68
    s_add_u32 s58, s61, s62
    s_mul_i32 s60, s60, 5760
    s_and_b32 s60, s60, 24448
    s_lshr_b32 s61, s36, 2
    s_mul_i32 s61, s61, 0x6000
    s_xor_b32 s60, s60, s61
    v_lshlrev_b32 v56, 5, v0
    v_xor_b32 v56, s60, v56
    ds_read_b128 v[152:155], v6 offset:4096
    ds_read_b128 v[156:159], v6 offset:5120
    v_bfe_u32 v28, v4, 2, 2
    v_and_b32_e64 v29, 0x33, v4
    v_lshl_add_u32 v28, v28, 6, v29
    v_lshlrev_b32_e64 v28, 2, v28
    v_lshl_add_u32 v28, s36, 10, v28
    v_add_u32 v29, 8192, v28
    ds_read2_b32 v[80:81], v28 offset0:0 offset1:4
    ds_read2_b32 v[82:83], v28 offset0:8 offset1:12
    ds_read2_b32 v[92:93], v29 offset0:0 offset1:4
    ds_read2_b32 v[94:95], v29 offset0:8 offset1:12
    s_nop 0
    s_waitcnt vmcnt(4)
    v_perm_b32 v144, v72, v68, s46
    v_perm_b32 v145, v72, v68, s47
    v_perm_b32 v146, v73, v69, s46
    v_perm_b32 v147, v73, v69, s47
    v_perm_b32 v148, v74, v70, s46
    v_perm_b32 v149, v74, v70, s47
    s_mov_b32 exec_hi, 0x3fffff
    ds_write_b64 v59, v[144:145] offset:41472
    ds_write_b64 v59, v[146:147] offset:41480
    ds_write_b64 v59, v[148:149] offset:41488
    s_mov_b32 exec_hi, -1
    s_waitcnt lgkmcnt(0)
    s_barrier
    s_and_b32 s60, s2, 3
    s_lshl_b32 s60, s60, 2
    s_lshr_b32 s61, s36, 2
    s_add_u32 s60, s60, s61
    s_lshl_b32 s60, s60, 13
    s_add_u32 s60, s60, s68
    s_add_u32 s69, s60, 393216
    v_and_b32 v75, 0x1fe0, v11
    v_add_u32 v75, v75, v11
    buffer_load_dwordx4 v[188:191], v75, s[12:15], s69 offen sc1
    v_mov_b32_dpp v212, v140 quad_perm:[0,2,0,2] row_mask:0xf bank_mask:0xf
    v_mov_b32_dpp v213, v141 quad_perm:[0,2,0,2] row_mask:0xf bank_mask:0xf
    v_mov_b32_dpp v214, v142 quad_perm:[0,2,0,2] row_mask:0xf bank_mask:0xf
    v_mov_b32_dpp v215, v143 quad_perm:[0,2,0,2] row_mask:0xf bank_mask:0xf
    v_mov_b32_dpp v216, v140 quad_perm:[1,3,1,3] row_mask:0xf bank_mask:0xf
    v_mov_b32_dpp v217, v141 quad_perm:[1,3,1,3] row_mask:0xf bank_mask:0xf
    v_mov_b32_dpp v218, v142 quad_perm:[1,3,1,3] row_mask:0xf bank_mask:0xf
    v_mov_b32_dpp v219, v143 quad_perm:[1,3,1,3] row_mask:0xf bank_mask:0xf
    s_cmp_eq_u32 s2, 159
    s_cselect_b32 s60, 0, -1
    s_cselect_b32 s59, 0x3f3504f3, 1.0
    v_and_b32 v192, s60, v20
    v_and_b32 v193, s60, v21
    v_and_b32 v194, s60, v22
    v_and_b32 v195, s60, v23
    v_lshrrev_b32 v28, 5, v4
    v_and_b32 v29, 0x7c, v5
    v_lshl_add_u32 v28, v28, 12, v29
    v_lshl_add_u32 v71, s36, 7, v28
    s_nop 0
    s_waitcnt lgkmcnt(0)
    v_alignbit_b32 v96, v92, v92, 16
    v_xor_b32 v92, 0x80000000, v92
    v_alignbit_b32 v97, v93, v93, 16
    v_xor_b32 v93, 0x80000000, v93
    v_alignbit_b32 v98, v94, v94, 16
    v_xor_b32 v94, 0x80000000, v94
    v_alignbit_b32 v99, v95, v95, 16
    v_xor_b32 v95, 0x80000000, v95
    s_lshr_b32 s3, s64, 8
    s_lshr_b32 s41, s64, 16
    s_lshr_b32 s63, s64, 24
    s_waitcnt vmcnt(0)
L_stop_5:
    v_xor_b32_e64 v29, s64, v188
    v_bitop3_b32 v29, v189, s3, v29 bitop3:0xbe
    v_bitop3_b32 v29, v190, s41, v29 bitop3:0xbe
    v_bitop3_b32 v29, v191, s63, v29 bitop3:0xbe
    v_and_b32 v29, 0xff, v29
    v_cmp_ne_u32 vcc, 0, v29
    s_nop 0
    s_nop 0
    s_cbranch_vccnz L_retry_7
L_sok_6:
    s_add_u32 s60, s58, 16777216
    buffer_load_dwordx4 v[112:115], v56, s[12:15], s60 offen sc1
    buffer_load_dwordx4 v[116:119], v56, s[12:15], s60 offen offset:16 sc1
    ds_read2st64_b32 v[160:161], v168 offset0:49 offset1:55
    ds_read2st64_b32 v[162:163], v168 offset0:61 offset1:67
    ds_read2st64_b32 v[164:165], v169 offset0:49 offset1:55
    ds_read2st64_b32 v[166:167], v169 offset0:61 offset1:67
    s_nop 0
    s_waitcnt lgkmcnt(0)
    v_or3_b32 v144, v160, v161, v162
    s_mov_b64 exec, 0xffff
    v_or3_b32 v144, v164, v165, v144
    v_or3_b32 v144, v166, v167, v144
    s_mov_b64 exec, -1
    v_bitop3_b32 v144, v144, v163, s45 bitop3:0xa8
    v_cmp_ne_u32 vcc, 0, v144
    s_nop 0
    s_cmp_eq_u64 vcc, 0
    s_nop 0
    s_cselect_b32 s61, 0, s45
    v_bitop3_b32 v160, v160, v140, s61 bitop3:0x76
    v_bitop3_b32 v161, v161, v141, s61 bitop3:0x76
    v_bitop3_b32 v162, v162, v142, s61 bitop3:0x76
    v_bitop3_b32 v163, v163, v143, s61 bitop3:0x76
    v_bitop3_b32 v164, v164, v140, s61 bitop3:0x76
    v_bitop3_b32 v165, v165, v141, s61 bitop3:0x76
    v_bitop3_b32 v166, v166, v142, s61 bitop3:0x76
    v_bitop3_b32 v167, v167, v143, s61 bitop3:0x76
    s_and_b32 s60, s2, 3
    s_xor_b32 s60, s60, s77
    s_lshl_b32 s60, s60, 14
    s_add_u32 s60, s60, s68
    s_add_u32 s57, s60, 131072
    s_lshr_b32 s62, s36, 1
    s_mul_i32 s60, s62, 40
    s_lshr_b32 s61, s2, 3
    s_add_u32 s60, s60, s61
    v_lshrrev_b32_e64 v30, 5, v4
    v_mad_u32_u24 v28, v30, 20, s60
    v_and_b32 v29, 0xf8, v28
    v_lshrrev_b32_e64 v31, 3, v28
    v_mad_u32_u24 v28, v29, 3, v28
    v_xor_b32_e64 v31, v31, v4
    v_and_or_b32 v28, v31, 16, v28
    s_lshl_b32 s60, s36, 2
    s_xor_b32 s60, s60, s2
    s_and_b32 s60, s60, 7
    s_lshl_b32 s60, s60, 7
    s_lshl_b32 s61, s77, 14
    s_or_b32 s60, s60, s61
    v_lshlrev_b32_e64 v29, 3, v4
    v_lshl_or_b32 v28, v28, 10, v29
    v_lshrrev_b32 v30, 4, v4
    v_xor_b32 v128, s60, v28
    s_and_b32 s60, s36, 1
    s_lshl_b32 s60, s60, 2
    s_lshr_b32 s60, s67, s60
    v_bfe_u32 v30, s60, v30, 1
    v_lshl_or_b32 v128, v30, 13, v128
    s_lshr_b32 s62, s2, 3
    s_lshl2_add_u32 s62, s36, s62
    s_and_b32 s60, s62, 7
    s_lshr_b32 s60, s67, s60
    s_and_b32 s60, s60, 1
    s_lshl_b32 s60, s60, 13
    s_xor_b32 s61, s62, s77
    s_and_b32 s61, s61, 1
    s_lshl_b32 s61, s61, 14
    s_add_u32 s60, s60, s61
    s_and_b32 s61, s62, 24
    s_lshl_b32 s61, s61, 8
    s_add_u32 s60, s60, s61
    s_and_b32 s61, s62, 2
    s_lshl_b32 s61, s61, 9
    s_add_u32 s60, s60, s61
    s_add_u32 s80, s60, 327680
    s_and_b32 s60, s2, 7
    s_lshl_b32 s60, s60, 7
    s_add_u32 s80, s60, s80
    s_cmp_lt_u32 s2, 32
    s_cselect_b32 s80, s80, 0
    v_and_b32 v188, 0xffffff00, v188
    v_and_b32 v189, 0xffffff00, v189
    v_and_b32 v190, 0xffffff00, v190
    v_and_b32 v191, 0xffffff00, v191
    s_nop 0
    s_waitcnt vmcnt(0) lgkmcnt(0)
L_htop_9:
    v_xor_b32_dpp v112, v136, v112 quad_perm:[0,2,0,2] row_mask:0xf bank_mask:0xf
    v_xor_b32_dpp v113, v137, v113 quad_perm:[0,2,0,2] row_mask:0xf bank_mask:0xf
    v_xor_b32_dpp v114, v138, v114 quad_perm:[0,2,0,2] row_mask:0xf bank_mask:0xf
    v_xor_b32_dpp v115, v139, v115 quad_perm:[0,2,0,2] row_mask:0xf bank_mask:0xf
    v_xor_b32_dpp v116, v136, v116 quad_perm:[1,3,1,3] row_mask:0xf bank_mask:0xf
    v_xor_b32_dpp v117, v137, v117 quad_perm:[1,3,1,3] row_mask:0xf bank_mask:0xf
    v_xor_b32_dpp v118, v138, v118 quad_perm:[1,3,1,3] row_mask:0xf bank_mask:0xf
    v_xor_b32_dpp v119, v139, v119 quad_perm:[1,3,1,3] row_mask:0xf bank_mask:0xf
    v_or3_b32 v28, v112, v113, v114
    v_or3_b32 v29, v115, v116, v117
    v_or3_b32 v28, v118, v119, v28
    v_bitop3_b32 v28, v28, v29, s44 bitop3:0xa8
    v_cmp_ne_u32 vcc, 0, v28
    s_nop 0
    s_cbranch_vccnz L_retry_11
L_hok_10:
    s_mov_b64 exec, -1
    s_add_u32 s60, s58, 20971520
    buffer_load_dwordx4 v[104:107], v56, s[12:15], s60 offen sc1
    buffer_load_dwordx4 v[108:111], v56, s[12:15], s60 offen offset:16 sc1
    v_mfma_f32_16x16x32_f16 v[40:43], v[112:115], v[20:23], 0
    v_mfma_f32_16x16x32_f16 v[44:47], v[112:115], v[24:27], 0
    s_cmp_eq_u32 s2, 159
    s_cbranch_scc1 L_nyq
L_nyq_ret:
    s_nop 0
    v_mfma_f32_16x16x32_f16 v[48:51], v[116:119], v[20:23], 0
    v_mfma_f32_16x16x32_f16 v[52:55], v[116:119], v[24:27], 0
    s_nop 1
    s_nop 0
    v_cvt_pk_f16_f32 v204, v40, v44
    v_cvt_pk_f16_f32 v205, v41, v45
    v_cvt_pk_f16_f32 v206, v42, v46
    v_cvt_pk_f16_f32 v207, v43, v47
    v_pk_mul_f16 v28, v204, v76 op_sel:[0,0] op_sel_hi:[1,0]
    v_pk_mul_f16 v29, v205, v77 op_sel:[0,0] op_sel_hi:[1,0]
    v_pk_mul_f16 v30, v206, v78 op_sel:[0,0] op_sel_hi:[1,0]
    v_pk_mul_f16 v31, v207, v79 op_sel:[0,0] op_sel_hi:[1,0]
    v_pk_fma_f16 v196, v204, v76, v28 op_sel:[1,1,0] op_sel_hi:[0,1,1] neg_hi:[1,0,0]
    v_pk_fma_f16 v197, v205, v77, v29 op_sel:[1,1,0] op_sel_hi:[0,1,1] neg_hi:[1,0,0]
    v_pk_fma_f16 v198, v206, v78, v30 op_sel:[1,1,0] op_sel_hi:[0,1,1] neg_hi:[1,0,0]
    v_pk_fma_f16 v199, v207, v79, v31 op_sel:[1,1,0] op_sel_hi:[0,1,1] neg_hi:[1,0,0]
    s_nop 0
    s_nop 0
    v_mfma_f32_16x16x32_f16 v[40:43], v[84:87], v[196:199], 0
    v_mfma_f32_16x16x32_f16 v[44:47], v[88:91], v[196:199], 0
    v_cvt_pk_f16_f32 v208, v48, v52
    v_cvt_pk_f16_f32 v209, v49, v53
    v_cvt_pk_f16_f32 v210, v50, v54
    v_cvt_pk_f16_f32 v211, v51, v55
    v_pk_mul_f16 v32, v208, v76 op_sel:[0,0] op_sel_hi:[1,0]
    v_pk_mul_f16 v33, v209, v77 op_sel:[0,0] op_sel_hi:[1,0]
    v_pk_mul_f16 v34, v210, v78 op_sel:[0,0] op_sel_hi:[1,0]
    v_pk_mul_f16 v35, v211, v79 op_sel:[0,0] op_sel_hi:[1,0]
    v_pk_fma_f16 v200, v208, v76, v32 op_sel:[1,1,0] op_sel_hi:[0,1,1] neg_hi:[1,0,0]
    v_pk_fma_f16 v201, v209, v77, v33 op_sel:[1,1,0] op_sel_hi:[0,1,1] neg_hi:[1,0,0]
    v_pk_fma_f16 v202, v210, v78, v34 op_sel:[1,1,0] op_sel_hi:[0,1,1] neg_hi:[1,0,0]
    v_pk_fma_f16 v203, v211, v79, v35 op_sel:[1,1,0] op_sel_hi:[0,1,1] neg_hi:[1,0,0]
    s_nop 0
    s_nop 0
    v_mfma_f32_16x16x32_f16 v[48:51], v[84:87], v[200:203], 0
    v_mfma_f32_16x16x32_f16 v[52:55], v[88:91], v[200:203], 0
    v_cvt_pk_f16_f32 v204, v40, v44
    v_cvt_pk_f16_f32 v205, v41, v45
    v_cvt_pk_f16_f32 v206, v42, v46
    v_cvt_pk_f16_f32 v207, v43, v47
    ds_write_b128 v11, v[204:207] offset:0
    s_nop 1
    s_nop 0
    v_cvt_pk_f16_f32 v208, v48, v52
    v_cvt_pk_f16_f32 v209, v49, v53
    v_cvt_pk_f16_f32 v210, v50, v54
    v_cvt_pk_f16_f32 v211, v51, v55
    ds_write_b128 v11, v[208:211] offset:8192
    s_nop 0
    s_waitcnt vmcnt(0)
L_wtop_13:
    v_bitop3_b32 v220, v104, v212, s49 bitop3:0x28
    v_bitop3_b32 v221, v105, v213, s49 bitop3:0x28
    v_bitop3_b32 v222, v106, v214, s49 bitop3:0x28
    v_bitop3_b32 v223, v107, v215, s49 bitop3:0x28
    v_bitop3_b32 v224, v108, v216, s49 bitop3:0x28
    v_bitop3_b32 v225, v109, v217, s49 bitop3:0x28
    v_bitop3_b32 v226, v110, v218, s49 bitop3:0x28
    v_bitop3_b32 v227, v111, v219, s49 bitop3:0x28
    v_pk_maximum3_f16 v228, v220, v221, v222
    v_pk_maximum3_f16 v230, v223, v224, v225
    v_pk_maximum3_f16 v228, v226, v227, v228
    v_pk_max_u16 v228, v228, v230
    v_pk_max_u16 v228, v228, v228 op_sel:[0,1] op_sel_hi:[1,0]
    v_cmp_le_u32 vcc, s45, v228
    s_nop 0
    s_cbranch_vccnz L_wslow_15
L_wok_14:
    v_mov_b32 v229, 56064
    v_max_u32_dpp v228, v228, v228 row_ror:8 row_mask:0xf bank_mask:0xf
    s_nop 1
    v_max_u32_dpp v228, v228, v228 row_ror:4 row_mask:0xf bank_mask:0xf
    s_nop 1
    v_max_u32_dpp v228, v228, v228 row_ror:2 row_mask:0xf bank_mask:0xf
    s_nop 1
    v_max_u32_dpp v228, v228, v228 row_ror:1 row_mask:0xf bank_mask:0xf
    s_mov_b32 exec_lo, s44
    s_mov_b32 exec_hi, s44
    ds_max_u32 v229, v228
    s_mov_b64 exec, -1
    s_waitcnt lgkmcnt(0)
    s_barrier
    s_setprio 2
    ds_read_b32 v228, v229
    ds_read2st64_b32 v[196:197], v71 offset0:0 offset1:4
    ds_read2st64_b32 v[198:199], v71 offset0:8 offset1:12
    ds_read2st64_b32 v[200:201], v71 offset0:32 offset1:36
    ds_read2st64_b32 v[202:203], v71 offset0:40 offset1:44
    s_waitcnt lgkmcnt(2)
    v_mfma_f32_16x16x32_f16 v[40:43], v[152:155], v[196:199], 0
    v_mfma_f32_16x16x32_f16 v[44:47], v[156:159], v[196:199], 0
    s_waitcnt lgkmcnt(0)
    v_mfma_f32_16x16x32_f16 v[48:51], v[152:155], v[200:203], 0
    v_mfma_f32_16x16x32_f16 v[52:55], v[156:159], v[200:203], 0
    v_readfirstlane_b32 s60, v228
    s_nop 0
    s_lshr_b32 s60, s60, 23
    s_max_u32 s60, s60, 90
    s_min_u32 s60, s60, 200
    s_sub_u32 s61, s60, 14
    s_mul_i32 s70, s61, 0x00800080
    s_sub_u32 s61, s60, 6
    s_lshl_b32 s52, s61, 23
    s_sub_u32 s61, 260, s60
    s_nop 0
    s_lshl_b32 s54, s61, 23
    v_pk_sub_u16 v220, v220, s70 clamp
    v_pk_sub_u16 v221, v221, s70 clamp
    v_pk_sub_u16 v222, v222, s70 clamp
    v_pk_sub_u16 v223, v223, s70 clamp
    v_pk_sub_u16 v224, v224, s70 clamp
    v_pk_sub_u16 v225, v225, s70 clamp
    v_pk_sub_u16 v226, v226, s70 clamp
    v_pk_sub_u16 v227, v227, s70 clamp
    v_pk_lshlrev_b16 v220, 3, v220 op_sel_hi:[0,1]
    v_pk_lshlrev_b16 v221, 3, v221 op_sel_hi:[0,1]
    v_pk_lshlrev_b16 v222, 3, v222 op_sel_hi:[0,1]
    v_pk_lshlrev_b16 v223, 3, v223 op_sel_hi:[0,1]
    v_pk_lshlrev_b16 v224, 3, v224 op_sel_hi:[0,1]
    v_pk_lshlrev_b16 v225, 3, v225 op_sel_hi:[0,1]
    v_pk_lshlrev_b16 v226, 3, v226 op_sel_hi:[0,1]
    v_pk_lshlrev_b16 v227, 3, v227 op_sel_hi:[0,1]
    v_bfi_b32 v60, s48, v104, v220
    v_bfi_b32 v61, s48, v105, v221
    v_bfi_b32 v62, s48, v106, v222
    v_bfi_b32 v63, s48, v107, v223
    v_bfi_b32 v64, s48, v108, v224
    v_bfi_b32 v65, s48, v109, v225
    v_bfi_b32 v66, s48, v110, v226
    v_bfi_b32 v67, s48, v111, v227
    v_cvt_pk_f16_f32 v204, v40, v44
    v_cvt_pk_f16_f32 v205, v41, v45
    v_cvt_pk_f16_f32 v206, v42, v46
    v_cvt_pk_f16_f32 v207, v43, v47
    v_pk_mul_f16 v28, v204, v60 op_sel:[0,1] op_sel_hi:[0,0]
    v_pk_mul_f16 v29, v205, v61 op_sel:[0,1] op_sel_hi:[0,0]
    v_pk_mul_f16 v30, v206, v62 op_sel:[0,1] op_sel_hi:[0,0]
    v_pk_mul_f16 v31, v207, v63 op_sel:[0,1] op_sel_hi:[0,0]
    v_pk_fma_f16 v196, v204, v60, v28 op_sel:[1,0,0] op_sel_hi:[1,1,1] neg_hi:[1,0,0]
    v_pk_fma_f16 v197, v205, v61, v29 op_sel:[1,0,0] op_sel_hi:[1,1,1] neg_hi:[1,0,0]
    v_pk_fma_f16 v198, v206, v62, v30 op_sel:[1,0,0] op_sel_hi:[1,1,1] neg_hi:[1,0,0]
    v_pk_fma_f16 v199, v207, v63, v31 op_sel:[1,0,0] op_sel_hi:[1,1,1] neg_hi:[1,0,0]
    s_nop 1
    v_mfma_f32_16x16x32_f16 v[44:47], v[152:155], v[196:199], 0
    v_mfma_f32_16x16x32_f16 v[40:43], v[156:159], v[196:199], 0
    s_setprio 1
    v_cvt_pk_f16_f32 v208, v48, v52
    v_cvt_pk_f16_f32 v209, v49, v53
    v_cvt_pk_f16_f32 v210, v50, v54
    v_cvt_pk_f16_f32 v211, v51, v55
    v_pk_mul_f16 v32, v208, v64 op_sel:[0,1] op_sel_hi:[0,0]
    v_pk_mul_f16 v33, v209, v65 op_sel:[0,1] op_sel_hi:[0,0]
    v_pk_mul_f16 v34, v210, v66 op_sel:[0,1] op_sel_hi:[0,0]
    v_pk_mul_f16 v35, v211, v67 op_sel:[0,1] op_sel_hi:[0,0]
    v_pk_fma_f16 v200, v208, v64, v32 op_sel:[1,0,0] op_sel_hi:[1,1,1] neg_hi:[1,0,0]
    v_pk_fma_f16 v201, v209, v65, v33 op_sel:[1,0,0] op_sel_hi:[1,1,1] neg_hi:[1,0,0]
    v_pk_fma_f16 v202, v210, v66, v34 op_sel:[1,0,0] op_sel_hi:[1,1,1] neg_hi:[1,0,0]
    v_pk_fma_f16 v203, v211, v67, v35 op_sel:[1,0,0] op_sel_hi:[1,1,1] neg_hi:[1,0,0]
    s_nop 0
    s_nop 0
    v_mfma_f32_16x16x32_f16 v[52:55], v[152:155], v[200:203], 0
    v_mfma_f32_16x16x32_f16 v[48:51], v[156:159], v[200:203], 0
    v_cvt_pk_f16_f32 v204, v40, v44
    v_cvt_pk_f16_f32 v205, v41, v45
    ds_write2st64_b32 v71, v204, v205 offset0:0 offset1:4
    v_cvt_pk_f16_f32 v206, v42, v46
    v_cvt_pk_f16_f32 v207, v43, v47
    ds_write2st64_b32 v71, v206, v207 offset0:8 offset1:12
    s_setprio 0
    s_nop 0
    v_cvt_pk_f16_f32 v208, v48, v52
    v_cvt_pk_f16_f32 v209, v49, v53
    ds_write2st64_b32 v71, v208, v209 offset0:32 offset1:36
    v_cvt_pk_f16_f32 v210, v50, v54
    v_cvt_pk_f16_f32 v211, v51, v55
    ds_write2st64_b32 v71, v210, v211 offset0:40 offset1:44
    buffer_load_dwordx4 v[232:235], v11, s[12:15], s57 offen sc1
    s_mov_b32 s71, 25165824
    buffer_store_dwordx4 v[160:163], v130, s[12:15], s71 offen sc1
    s_mov_b64 exec, 0xffff
    buffer_store_dwordx4 v[164:167], v131, s[12:15], s71 offen sc1
    s_mov_b64 exec, -1
    v_mul_f32 v132, s54, v188
    v_mul_f32 v133, s54, v189
    v_mul_f32 v134, s54, v190
    v_mul_f32_e64 v135, s54, v191
    v_fma_mix_f32 v172, v112, v132, 0 op_sel_hi:[1,0,0]
    v_fma_mix_f32 v176, v112, v132, 0 op_sel:[1,0,0] op_sel_hi:[1,0,0]
    v_fma_mix_f32 v173, v113, v133, 0 op_sel_hi:[1,0,0]
    v_fma_mix_f32 v177, v113, v133, 0 op_sel:[1,0,0] op_sel_hi:[1,0,0]
    v_fma_mix_f32 v174, v114, v134, 0 op_sel_hi:[1,0,0]
    v_fma_mix_f32 v178, v114, v134, 0 op_sel:[1,0,0] op_sel_hi:[1,0,0]
    v_fma_mix_f32 v175, v115, v135, 0 op_sel_hi:[1,0,0]
    v_fma_mix_f32 v179, v115, v135, 0 op_sel:[1,0,0] op_sel_hi:[1,0,0]
    v_fma_mix_f32 v180, v116, v132, 0 op_sel_hi:[1,0,0]
    v_fma_mix_f32 v184, v116, v132, 0 op_sel:[1,0,0] op_sel_hi:[1,0,0]
    v_fma_mix_f32 v181, v117, v133, 0 op_sel_hi:[1,0,0]
    v_fma_mix_f32 v185, v117, v133, 0 op_sel:[1,0,0] op_sel_hi:[1,0,0]
    v_fma_mix_f32 v182, v118, v134, 0 op_sel_hi:[1,0,0]
    v_fma_mix_f32 v186, v118, v134, 0 op_sel:[1,0,0] op_sel_hi:[1,0,0]
    v_fma_mix_f32 v183, v119, v135, 0 op_sel_hi:[1,0,0]
    v_fma_mix_f32 v187, v119, v135, 0 op_sel:[1,0,0] op_sel_hi:[1,0,0]
    s_waitcnt lgkmcnt(0)
    s_barrier
    s_setprio 1
    ds_read_b128 v[196:199], v11 offset:0
    ds_read_b128 v[200:203], v11 offset:8192
    s_waitcnt lgkmcnt(1)
    v_mfma_f32_16x16x32_f16 v[40:43], v[196:199], v[92:95], 0
    v_mfma_f32_16x16x32_f16 v[44:47], v[196:199], v[96:99], 0
    s_waitcnt lgkmcnt(0)
    v_mfma_f32_16x16x32_f16 v[48:51], v[200:203], v[92:95], 0
    v_mfma_f32_16x16x32_f16 v[52:55], v[200:203], v[96:99], 0
    s_nop 4
    v_cvt_pk_f16_f32 v204, v40, v44
    v_cvt_pk_f16_f32 v205, v41, v45
    v_cvt_pk_f16_f32 v206, v42, v46
    v_cvt_pk_f16_f32 v207, v43, v47
    v_pk_mul_f16 v28, v204, v80 op_sel:[0,1] op_sel_hi:[0,0]
    v_pk_mul_f16 v29, v205, v81 op_sel:[0,1] op_sel_hi:[0,0]
    v_pk_mul_f16 v30, v206, v82 op_sel:[0,1] op_sel_hi:[0,0]
    v_pk_mul_f16 v31, v207, v83 op_sel:[0,1] op_sel_hi:[0,0]
    v_pk_fma_f16 v196, v204, v80, v28 op_sel:[1,0,0] op_sel_hi:[1,1,1] neg_hi:[1,0,0]
    v_pk_fma_f16 v197, v205, v81, v29 op_sel:[1,0,0] op_sel_hi:[1,1,1] neg_hi:[1,0,0]
    v_pk_fma_f16 v198, v206, v82, v30 op_sel:[1,0,0] op_sel_hi:[1,1,1] neg_hi:[1,0,0]
    v_pk_fma_f16 v199, v207, v83, v31 op_sel:[1,0,0] op_sel_hi:[1,1,1] neg_hi:[1,0,0]
    s_nop 0
    s_nop 0
    v_mfma_f32_16x16x32_f16 v[172:175], v[24:27], v[196:199], v[172:175]
    v_mfma_f32_16x16x32_f16 v[176:179], v[20:23], v[196:199], v[176:179]
    v_cvt_pk_f16_f32 v208, v48, v52
    v_cvt_pk_f16_f32 v209, v49, v53
    v_cvt_pk_f16_f32 v210, v50, v54
    v_cvt_pk_f16_f32 v211, v51, v55
    v_pk_mul_f16 v32, v208, v80 op_sel:[0,1] op_sel_hi:[0,0]
    v_pk_mul_f16 v33, v209, v81 op_sel:[0,1] op_sel_hi:[0,0]
    v_pk_mul_f16 v34, v210, v82 op_sel:[0,1] op_sel_hi:[0,0]
    v_pk_mul_f16 v35, v211, v83 op_sel:[0,1] op_sel_hi:[0,0]
    v_pk_fma_f16 v200, v208, v80, v32 op_sel:[1,0,0] op_sel_hi:[1,1,1] neg_hi:[1,0,0]
    v_pk_fma_f16 v201, v209, v81, v33 op_sel:[1,0,0] op_sel_hi:[1,1,1] neg_hi:[1,0,0]
    v_pk_fma_f16 v202, v210, v82, v34 op_sel:[1,0,0] op_sel_hi:[1,1,1] neg_hi:[1,0,0]
    v_pk_fma_f16 v203, v211, v83, v35 op_sel:[1,0,0] op_sel_hi:[1,1,1] neg_hi:[1,0,0]
    v_pk_mul_f32 v[132:133], v[172:173], v[172:173]
    v_pk_mul_f32 v[134:135], v[174:175], v[174:175]
    v_pk_fma_f32 v[132:133], v[176:177], v[176:177], v[132:133]
    v_pk_fma_f32 v[134:135], v[178:179], v[178:179], v[134:135]
    v_mfma_f32_16x16x32_f16 v[180:183], v[24:27], v[200:203], v[180:183]
    v_mfma_f32_16x16x32_f16 v[184:187], v[192:195], v[200:203], v[184:187]
    s_or_b32 s61, s64, 0x80000000
    s_waitcnt vmcnt(2)
L_rtop_18:
    v_xor_b32 v228, s61, v232
    v_bitop3_b32 v228, v233, s61, v228 bitop3:0xbe
    v_bitop3_b32 v228, v234, s61, v228 bitop3:0xbe
    v_bitop3_b32 v228, v235, s61, v228 bitop3:0xbe
    v_cmp_ne_u32 vcc, 0, v228
    s_nop 0
    s_cbranch_vccnz L_retry_20
L_rok_19:
    v_mul_f32 v228, s52, s52
    s_mov_b32 s60, 4194304
    s_cmp_eq_u32 s80, 0
    s_cbranch_scc1 L_nohu_22
    s_add_u32 s61, s64, 0
    s_mov_b64 exec, 1
    v_mov_b32 v231, s61
    buffer_store_dword v231, off, s[12:15], s80 sc1
    s_nop 0
    s_mov_b64 exec, -1
L_nohu_22:
    v_pk_fma_f32 v[132:133], v[180:181], v[180:181], v[132:133]
    v_pk_fma_f32 v[134:135], v[182:183], v[182:183], v[134:135]
    v_pk_fma_f32 v[132:133], v[184:185], v[184:185], v[132:133]
    v_pk_fma_f32 v[134:135], v[186:187], v[186:187], v[134:135]
    v_pk_mul_f32 v[28:29], v[132:133], v[228:229] op_sel_hi:[1,0]
    v_pk_mul_f32 v[30:31], v[134:135], v[228:229] op_sel_hi:[1,0]
    v_cvt_pk_bf16_f32 v34, v28, v29
    v_cvt_pk_bf16_f32 v35, v30, v31
    buffer_store_dwordx2 v[34:35], v128, s[12:15], s60 offen sc1
    s_nop 0
    s_setprio 0
    v_max_f32 v132, 0x0da24260, v132
    v_max_f32 v133, 0x0da24260, v133
    v_max_f32 v134, 0x0da24260, v134
    v_max_f32 v135, 0x0da24260, v135
    v_rsq_f32 v28, v132
    v_rsq_f32 v29, v133
    v_rsq_f32 v30, v134
    v_rsq_f32 v31, v135
    v_pk_mul_f32 v[40:41], v[172:173], v[28:29]
    v_pk_mul_f32 v[42:43], v[174:175], v[30:31]
    v_pk_mul_f32 v[44:45], v[176:177], v[28:29]
    v_pk_mul_f32 v[46:47], v[178:179], v[30:31]
    v_pk_mul_f32 v[48:49], v[180:181], v[28:29]
    v_pk_mul_f32 v[50:51], v[182:183], v[30:31]
    v_pk_mul_f32 v[52:53], v[184:185], v[28:29]
    v_pk_mul_f32 v[54:55], v[186:187], v[30:31]
    v_cvt_pk_f16_f32 v120, v40, v44
    v_cvt_pk_f16_f32 v121, v41, v45
    v_cvt_pk_f16_f32 v122, v42, v46
    v_cvt_pk_f16_f32 v123, v43, v47
    v_cvt_pk_f16_f32 v124, v48, v52
    v_cvt_pk_f16_f32 v125, v49, v53
    v_cvt_pk_f16_f32 v126, v50, v54
    v_cvt_pk_f16_f32 v127, v51, v55
    v_mul_f32 v28, s52, v28
    v_mul_f32 v132, v132, v28
    v_mul_f32 v29, s52, v29
    v_mul_f32 v133, v133, v29
    v_mul_f32 v30, s52, v30
    v_mul_f32 v134, v134, v30
    v_mul_f32 v31, s52, v31
    v_mul_f32 v135, v135, v31
    s_nop 0
    s_call_b64 s[78:79], L_r1prep
    s_add_u32 s60, s58, 25165824
    buffer_load_dwordx4 v[104:107], v56, s[12:15], s60 offen sc1
    buffer_load_dwordx4 v[108:111], v56, s[12:15], s60 offen offset:16 sc1
    s_nop 0
    s_waitcnt vmcnt(0)
L_wtop_23:
    v_bitop3_b32 v220, v104, v212, s49 bitop3:0x28
    v_bitop3_b32 v221, v105, v213, s49 bitop3:0x28
    v_bitop3_b32 v222, v106, v214, s49 bitop3:0x28
    v_bitop3_b32 v223, v107, v215, s49 bitop3:0x28
    v_bitop3_b32 v224, v108, v216, s49 bitop3:0x28
    v_bitop3_b32 v225, v109, v217, s49 bitop3:0x28
    v_bitop3_b32 v226, v110, v218, s49 bitop3:0x28
    v_bitop3_b32 v227, v111, v219, s49 bitop3:0x28
    v_pk_maximum3_f16 v228, v220, v221, v222
    v_pk_maximum3_f16 v230, v223, v224, v225
    v_pk_maximum3_f16 v228, v226, v227, v228
    v_pk_max_u16 v228, v228, v230
    v_pk_max_u16 v228, v228, v228 op_sel:[0,1] op_sel_hi:[1,0]
    v_cmp_le_u32 vcc, s45, v228
    s_nop 0
    s_cbranch_vccnz L_wslow_25
L_wok_24:
    v_mov_b32 v229, 56068
    v_max_u32_dpp v228, v228, v228 row_ror:8 row_mask:0xf bank_mask:0xf
    s_nop 1
    v_max_u32_dpp v228, v228, v228 row_ror:4 row_mask:0xf bank_mask:0xf
    s_nop 1
    v_max_u32_dpp v228, v228, v228 row_ror:2 row_mask:0xf bank_mask:0xf
    s_nop 1
    v_max_u32_dpp v228, v228, v228 row_ror:1 row_mask:0xf bank_mask:0xf
    s_mov_b32 exec_lo, s44
    s_mov_b32 exec_hi, s44
    ds_max_u32 v229, v228
    s_mov_b64 exec, -1
    s_waitcnt lgkmcnt(0)
    s_barrier
    ds_read_b32 v228, v229
    s_waitcnt lgkmcnt(0)
    v_readfirstlane_b32 s60, v228
    s_nop 0
    s_lshr_b32 s60, s60, 23
    s_max_u32 s60, s60, 90
    s_min_u32 s60, s60, 200
    s_sub_u32 s61, s60, 14
    s_mul_i32 s70, s61, 0x00800080
    s_sub_u32 s61, s60, 6
    s_lshl_b32 s53, s61, 23
    s_sub_u32 s61, 260, s60
    s_nop 0
    s_lshl_b32 s55, s61, 23
    v_pk_sub_u16 v220, v220, s70 clamp
    v_pk_sub_u16 v221, v221, s70 clamp
    v_pk_sub_u16 v222, v222, s70 clamp
    v_pk_sub_u16 v223, v223, s70 clamp
    v_pk_sub_u16 v224, v224, s70 clamp
    v_pk_sub_u16 v225, v225, s70 clamp
    v_pk_sub_u16 v226, v226, s70 clamp
    v_pk_sub_u16 v227, v227, s70 clamp
    v_pk_lshlrev_b16 v220, 3, v220 op_sel_hi:[0,1]
    v_pk_lshlrev_b16 v221, 3, v221 op_sel_hi:[0,1]
    v_pk_lshlrev_b16 v222, 3, v222 op_sel_hi:[0,1]
    v_pk_lshlrev_b16 v223, 3, v223 op_sel_hi:[0,1]
    v_pk_lshlrev_b16 v224, 3, v224 op_sel_hi:[0,1]
    v_pk_lshlrev_b16 v225, 3, v225 op_sel_hi:[0,1]
    v_pk_lshlrev_b16 v226, 3, v226 op_sel_hi:[0,1]
    v_pk_lshlrev_b16 v227, 3, v227 op_sel_hi:[0,1]
    v_bfi_b32 v104, s48, v104, v220
    v_bfi_b32 v105, s48, v105, v221
    v_bfi_b32 v106, s48, v106, v222
    v_bfi_b32 v107, s48, v107, v223
    v_bfi_b32 v108, s48, v108, v224
    v_bfi_b32 v109, s48, v109, v225
    v_bfi_b32 v110, s48, v110, v226
    v_bfi_b32 v111, s48, v111, v227
    v_mov_b32 v28, s52
    v_mul_f32 v28, s55, v28
    v_pk_mul_f32 v[172:173], v[172:173], v[28:29] op_sel_hi:[1,0]
    v_pk_mul_f32 v[174:175], v[174:175], v[28:29] op_sel_hi:[1,0]
    v_pk_mul_f32 v[176:177], v[176:177], v[28:29] op_sel_hi:[1,0]
    v_pk_mul_f32 v[178:179], v[178:179], v[28:29] op_sel_hi:[1,0]
    v_pk_mul_f32 v[180:181], v[180:181], v[28:29] op_sel_hi:[1,0]
    v_pk_mul_f32 v[182:183], v[182:183], v[28:29] op_sel_hi:[1,0]
    v_pk_mul_f32 v[184:185], v[184:185], v[28:29] op_sel_hi:[1,0]
    v_pk_mul_f32 v[186:187], v[186:187], v[28:29] op_sel_hi:[1,0]
L_rstop_28:
    buffer_load_dwordx4 v[232:235], v11, s[12:15], s57 offen sc1
    s_sub_u32 s42, s42, 1
    s_cbranch_scc1 L_to_30
    s_waitcnt vmcnt(0)
    v_or3_b32 v32, v232, v233, v234
    v_or_b32 v32, v32, v235
    v_cmp_gt_i32 vcc, 0, v32
    s_nop 0
    s_nop 0
    s_cbranch_vccnz L_rstop_28
L_rsok_29:
    v_pk_mul_f32 v[28:29], v[232:233], v[132:133]
    v_pk_mul_f32 v[30:31], v[234:235], v[134:135]
    v_cvt_pk_f16_f32 v102, v28, v29
    v_cvt_pk_f16_f32 v103, v30, v31
    s_add_u32 s57, s57, 0x10000
    v_pk_mul_f16 v196, v120, v102 op_sel:[0,0] op_sel_hi:[1,0]
    v_pk_mul_f16 v197, v121, v102 op_sel:[0,1] op_sel_hi:[1,1]
    v_pk_mul_f16 v198, v122, v103 op_sel:[0,0] op_sel_hi:[1,0]
    v_pk_mul_f16 v199, v123, v103 op_sel:[0,1] op_sel_hi:[1,1]
    s_nop 0
    s_nop 0
    v_mfma_f32_16x16x32_f16 v[40:43], v[196:199], v[20:23], 0
    v_mfma_f32_16x16x32_f16 v[44:47], v[196:199], v[24:27], 0
    v_pk_mul_f16 v200, v124, v102 op_sel:[0,0] op_sel_hi:[1,0]
    v_pk_mul_f16 v201, v125, v102 op_sel:[0,1] op_sel_hi:[1,1]
    v_pk_mul_f16 v202, v126, v103 op_sel:[0,0] op_sel_hi:[1,0]
    v_pk_mul_f16 v203, v127, v103 op_sel:[0,1] op_sel_hi:[1,1]
    s_nop 0
    s_nop 0
    v_mfma_f32_16x16x32_f16 v[48:51], v[200:203], v[20:23], 0
    v_mfma_f32_16x16x32_f16 v[52:55], v[200:203], v[24:27], 0
    v_cvt_pk_f16_f32 v204, v40, v44
    v_cvt_pk_f16_f32 v205, v41, v45
    v_cvt_pk_f16_f32 v206, v42, v46
    v_cvt_pk_f16_f32 v207, v43, v47
    v_pk_mul_f16 v28, v204, v76 op_sel:[0,0] op_sel_hi:[1,0]
    v_pk_mul_f16 v29, v205, v77 op_sel:[0,0] op_sel_hi:[1,0]
    v_pk_mul_f16 v30, v206, v78 op_sel:[0,0] op_sel_hi:[1,0]
    v_pk_mul_f16 v31, v207, v79 op_sel:[0,0] op_sel_hi:[1,0]
    v_pk_fma_f16 v196, v204, v76, v28 op_sel:[1,1,0] op_sel_hi:[0,1,1] neg_hi:[1,0,0]
    v_pk_fma_f16 v197, v205, v77, v29 op_sel:[1,1,0] op_sel_hi:[0,1,1] neg_hi:[1,0,0]
    v_pk_fma_f16 v198, v206, v78, v30 op_sel:[1,1,0] op_sel_hi:[0,1,1] neg_hi:[1,0,0]
    v_pk_fma_f16 v199, v207, v79, v31 op_sel:[1,1,0] op_sel_hi:[0,1,1] neg_hi:[1,0,0]
    s_nop 0
    s_nop 0
    v_mfma_f32_16x16x32_f16 v[40:43], v[84:87], v[196:199], 0
    v_mfma_f32_16x16x32_f16 v[44:47], v[88:91], v[196:199], 0
    v_cvt_pk_f16_f32 v208, v48, v52
    v_cvt_pk_f16_f32 v209, v49, v53
    v_cvt_pk_f16_f32 v210, v50, v54
    v_cvt_pk_f16_f32 v211, v51, v55
    v_pk_mul_f16 v32, v208, v76 op_sel:[0,0] op_sel_hi:[1,0]
    v_pk_mul_f16 v33, v209, v77 op_sel:[0,0] op_sel_hi:[1,0]
    v_pk_mul_f16 v34, v210, v78 op_sel:[0,0] op_sel_hi:[1,0]
    v_pk_mul_f16 v35, v211, v79 op_sel:[0,0] op_sel_hi:[1,0]
    v_pk_fma_f16 v200, v208, v76, v32 op_sel:[1,1,0] op_sel_hi:[0,1,1] neg_hi:[1,0,0]
    v_pk_fma_f16 v201, v209, v77, v33 op_sel:[1,1,0] op_sel_hi:[0,1,1] neg_hi:[1,0,0]
    v_pk_fma_f16 v202, v210, v78, v34 op_sel:[1,1,0] op_sel_hi:[0,1,1] neg_hi:[1,0,0]
    v_pk_fma_f16 v203, v211, v79, v35 op_sel:[1,1,0] op_sel_hi:[0,1,1] neg_hi:[1,0,0]
    s_nop 0
    s_nop 0
    v_mfma_f32_16x16x32_f16 v[48:51], v[84:87], v[200:203], 0
    v_mfma_f32_16x16x32_f16 v[52:55], v[88:91], v[200:203], 0
    v_cvt_pk_f16_f32 v204, v40, v44
    v_cvt_pk_f16_f32 v205, v41, v45
    v_cvt_pk_f16_f32 v206, v42, v46
    v_cvt_pk_f16_f32 v207, v43, v47
    ds_write_b128 v11, v[204:207] offset:0
    s_nop 1
    s_nop 0
    v_cvt_pk_f16_f32 v208, v48, v52
    v_cvt_pk_f16_f32 v209, v49, v53
    v_cvt_pk_f16_f32 v210, v50, v54
    v_cvt_pk_f16_f32 v211, v51, v55
    ds_write_b128 v11, v[208:211] offset:8192
    s_waitcnt lgkmcnt(0)
    s_barrier
    s_nop 0
    s_setprio 2
    ds_read2st64_b32 v[196:197], v71 offset0:0 offset1:4
    ds_read2st64_b32 v[198:199], v71 offset0:8 offset1:12
    ds_read2st64_b32 v[200:201], v71 offset0:32 offset1:36
    ds_read2st64_b32 v[202:203], v71 offset0:40 offset1:44
    s_nop 0
    s_lshl_b32 s60, s2, 14
    s_add_u32 s60, s60, 16777216
    s_add_u32 s61, s60, 8192
    buffer_store_dwordx4 v[36:39], v11, s[12:15], s60 offen sc1
    buffer_store_dwordx4 v[36:39], v11, s[12:15], s61 offen sc1
    s_waitcnt lgkmcnt(2)
    v_mfma_f32_16x16x32_f16 v[40:43], v[152:155], v[196:199], 0
    v_mfma_f32_16x16x32_f16 v[44:47], v[156:159], v[196:199], 0
    s_waitcnt lgkmcnt(0)
    v_mfma_f32_16x16x32_f16 v[48:51], v[152:155], v[200:203], 0
    v_mfma_f32_16x16x32_f16 v[52:55], v[156:159], v[200:203], 0
    s_nop 3
    s_nop 0
    v_cvt_pk_f16_f32 v204, v40, v44
    v_cvt_pk_f16_f32 v205, v41, v45
    v_cvt_pk_f16_f32 v206, v42, v46
    v_cvt_pk_f16_f32 v207, v43, v47
    v_pk_mul_f16 v28, v204, v104 op_sel:[0,1] op_sel_hi:[0,0]
    v_pk_mul_f16 v29, v205, v105 op_sel:[0,1] op_sel_hi:[0,0]
    v_pk_mul_f16 v30, v206, v106 op_sel:[0,1] op_sel_hi:[0,0]
    v_pk_mul_f16 v31, v207, v107 op_sel:[0,1] op_sel_hi:[0,0]
    v_pk_fma_f16 v196, v204, v104, v28 op_sel:[1,0,0] op_sel_hi:[1,1,1] neg_hi:[1,0,0]
    v_pk_fma_f16 v197, v205, v105, v29 op_sel:[1,0,0] op_sel_hi:[1,1,1] neg_hi:[1,0,0]
    v_pk_fma_f16 v198, v206, v106, v30 op_sel:[1,0,0] op_sel_hi:[1,1,1] neg_hi:[1,0,0]
    v_pk_fma_f16 v199, v207, v107, v31 op_sel:[1,0,0] op_sel_hi:[1,1,1] neg_hi:[1,0,0]
    s_nop 1
    v_mfma_f32_16x16x32_f16 v[44:47], v[152:155], v[196:199], 0
    v_mfma_f32_16x16x32_f16 v[40:43], v[156:159], v[196:199], 0
    s_setprio 1
    v_cvt_pk_f16_f32 v208, v48, v52
    v_cvt_pk_f16_f32 v209, v49, v53
    v_cvt_pk_f16_f32 v210, v50, v54
    v_cvt_pk_f16_f32 v211, v51, v55
    v_pk_mul_f16 v32, v208, v108 op_sel:[0,1] op_sel_hi:[0,0]
    v_pk_mul_f16 v33, v209, v109 op_sel:[0,1] op_sel_hi:[0,0]
    v_pk_mul_f16 v34, v210, v110 op_sel:[0,1] op_sel_hi:[0,0]
    v_pk_mul_f16 v35, v211, v111 op_sel:[0,1] op_sel_hi:[0,0]
    v_pk_fma_f16 v200, v208, v108, v32 op_sel:[1,0,0] op_sel_hi:[1,1,1] neg_hi:[1,0,0]
    v_pk_fma_f16 v201, v209, v109, v33 op_sel:[1,0,0] op_sel_hi:[1,1,1] neg_hi:[1,0,0]
    v_pk_fma_f16 v202, v210, v110, v34 op_sel:[1,0,0] op_sel_hi:[1,1,1] neg_hi:[1,0,0]
    v_pk_fma_f16 v203, v211, v111, v35 op_sel:[1,0,0] op_sel_hi:[1,1,1] neg_hi:[1,0,0]
    s_nop 0
    s_nop 0
    v_mfma_f32_16x16x32_f16 v[52:55], v[152:155], v[200:203], 0
    v_mfma_f32_16x16x32_f16 v[48:51], v[156:159], v[200:203], 0
    v_cvt_pk_f16_f32 v204, v40, v44
    v_cvt_pk_f16_f32 v205, v41, v45
    ds_write2st64_b32 v71, v204, v205 offset0:0 offset1:4
    v_cvt_pk_f16_f32 v206, v42, v46
    v_cvt_pk_f16_f32 v207, v43, v47
    ds_write2st64_b32 v71, v206, v207 offset0:8 offset1:12
    s_setprio 0
    s_nop 0
    v_cvt_pk_f16_f32 v208, v48, v52
    v_cvt_pk_f16_f32 v209, v49, v53
    ds_write2st64_b32 v71, v208, v209 offset0:32 offset1:36
    v_cvt_pk_f16_f32 v210, v50, v54
    v_cvt_pk_f16_f32 v211, v51, v55
    ds_write2st64_b32 v71, v210, v211 offset0:40 offset1:44
    s_cmp_eq_u32 s80, 0
    s_cbranch_scc1 L_nohu_31
    s_add_u32 s61, s64, 1
    s_mov_b64 exec, 1
    v_mov_b32_e64 v231, s61
    buffer_store_dword v231, off, s[12:15], s80 sc1
    s_mov_b64 exec, -1
L_nohu_31:
    s_waitcnt lgkmcnt(0)
    s_barrier
    s_setprio 1
    ds_read_b128 v[196:199], v11 offset:0
    ds_read_b128 v[200:203], v11 offset:8192
    s_waitcnt lgkmcnt(1)
    v_mfma_f32_16x16x32_f16 v[40:43], v[196:199], v[92:95], 0
    v_mfma_f32_16x16x32_f16 v[44:47], v[196:199], v[96:99], 0
    s_waitcnt lgkmcnt(0)
    v_mfma_f32_16x16x32_f16 v[48:51], v[200:203], v[92:95], 0
    v_mfma_f32_16x16x32_f16 v[52:55], v[200:203], v[96:99], 0
    s_nop 3
    s_nop 0
    v_cvt_pk_f16_f32 v204, v40, v44
    v_cvt_pk_f16_f32 v205, v41, v45
    v_cvt_pk_f16_f32 v206, v42, v46
    v_cvt_pk_f16_f32 v207, v43, v47
    v_pk_mul_f16 v28, v204, v80 op_sel:[0,1] op_sel_hi:[0,0]
    v_pk_mul_f16 v29, v205, v81 op_sel:[0,1] op_sel_hi:[0,0]
    v_pk_mul_f16 v30, v206, v82 op_sel:[0,1] op_sel_hi:[0,0]
    v_pk_mul_f16 v31, v207, v83 op_sel:[0,1] op_sel_hi:[0,0]
    v_pk_fma_f16 v196, v204, v80, v28 op_sel:[1,0,0] op_sel_hi:[1,1,1] neg_hi:[1,0,0]
    v_pk_fma_f16 v197, v205, v81, v29 op_sel:[1,0,0] op_sel_hi:[1,1,1] neg_hi:[1,0,0]
    v_pk_fma_f16 v198, v206, v82, v30 op_sel:[1,0,0] op_sel_hi:[1,1,1] neg_hi:[1,0,0]
    v_pk_fma_f16 v199, v207, v83, v31 op_sel:[1,0,0] op_sel_hi:[1,1,1] neg_hi:[1,0,0]
    s_nop 0
    s_nop 0
    v_mfma_f32_16x16x32_f16 v[172:175], v[24:27], v[196:199], v[172:175]
    v_mfma_f32_16x16x32_f16 v[176:179], v[20:23], v[196:199], v[176:179]
    v_cvt_pk_f16_f32 v208, v48, v52
    v_cvt_pk_f16_f32 v209, v49, v53
    v_cvt_pk_f16_f32 v210, v50, v54
    v_cvt_pk_f16_f32 v211, v51, v55
    v_pk_mul_f16 v32, v208, v80 op_sel:[0,1] op_sel_hi:[0,0]
    v_pk_mul_f16 v33, v209, v81 op_sel:[0,1] op_sel_hi:[0,0]
    v_pk_mul_f16 v34, v210, v82 op_sel:[0,1] op_sel_hi:[0,0]
    v_pk_mul_f16 v35, v211, v83 op_sel:[0,1] op_sel_hi:[0,0]
    v_pk_fma_f16 v200, v208, v80, v32 op_sel:[1,0,0] op_sel_hi:[1,1,1] neg_hi:[1,0,0]
    v_pk_fma_f16 v201, v209, v81, v33 op_sel:[1,0,0] op_sel_hi:[1,1,1] neg_hi:[1,0,0]
    v_pk_fma_f16 v202, v210, v82, v34 op_sel:[1,0,0] op_sel_hi:[1,1,1] neg_hi:[1,0,0]
    v_pk_fma_f16 v203, v211, v83, v35 op_sel:[1,0,0] op_sel_hi:[1,1,1] neg_hi:[1,0,0]
    v_pk_mul_f32 v[132:133], v[172:173], v[172:173]
    v_pk_mul_f32 v[134:135], v[174:175], v[174:175]
    v_pk_fma_f32 v[132:133], v[176:177], v[176:177], v[132:133]
    v_pk_fma_f32 v[134:135], v[178:179], v[178:179], v[134:135]
    v_mfma_f32_16x16x32_f16 v[180:183], v[24:27], v[200:203], v[180:183]
    v_mfma_f32_16x16x32_f16 v[184:187], v[192:195], v[200:203], v[184:187]
    v_mul_f32 v228, s53, s53
    s_mov_b32 s60, 5242880
    s_nop 3
    s_nop 0
    v_pk_fma_f32 v[132:133], v[180:181], v[180:181], v[132:133]
    v_pk_fma_f32 v[134:135], v[182:183], v[182:183], v[134:135]
    v_pk_fma_f32 v[132:133], v[184:185], v[184:185], v[132:133]
    v_pk_fma_f32 v[134:135], v[186:187], v[186:187], v[134:135]
    v_pk_mul_f32 v[28:29], v[132:133], v[228:229] op_sel_hi:[1,0]
    v_pk_mul_f32 v[30:31], v[134:135], v[228:229] op_sel_hi:[1,0]
    v_cvt_pk_bf16_f32 v34, v28, v29
    v_cvt_pk_bf16_f32 v35, v30, v31
    buffer_store_dwordx2 v[34:35], v128, s[12:15], s60 offen sc1
    s_nop 0
    s_setprio 0
    v_max_f32 v132, 0x0da24260, v132
    v_max_f32 v133, 0x0da24260, v133
    v_max_f32 v134, 0x0da24260, v134
    v_max_f32 v135, 0x0da24260, v135
    v_rsq_f32 v28, v132
    v_rsq_f32 v29, v133
    v_rsq_f32 v30, v134
    v_rsq_f32 v31, v135
    v_pk_mul_f32 v[40:41], v[172:173], v[28:29]
    v_pk_mul_f32 v[42:43], v[174:175], v[30:31]
    v_pk_mul_f32 v[44:45], v[176:177], v[28:29]
    v_pk_mul_f32 v[46:47], v[178:179], v[30:31]
    v_pk_mul_f32 v[48:49], v[180:181], v[28:29]
    v_pk_mul_f32 v[50:51], v[182:183], v[30:31]
    v_pk_mul_f32 v[52:53], v[184:185], v[28:29]
    v_pk_mul_f32 v[54:55], v[186:187], v[30:31]
    v_cvt_pk_f16_f32 v120, v40, v44
    v_cvt_pk_f16_f32 v121, v41, v45
    v_cvt_pk_f16_f32 v122, v42, v46
    v_cvt_pk_f16_f32 v123, v43, v47
    v_cvt_pk_f16_f32 v124, v48, v52
    v_cvt_pk_f16_f32 v125, v49, v53
    v_cvt_pk_f16_f32 v126, v50, v54
    v_cvt_pk_f16_f32 v127, v51, v55
    v_mul_f32 v28, s53, v28
    v_mul_f32 v132, v132, v28
    v_mul_f32 v29, s53, v29
    v_mul_f32 v133, v133, v29
    v_mul_f32 v30, s53, v30
    v_mul_f32 v134, v134, v30
    v_mul_f32 v31, s53, v31
    v_mul_f32 v135, v135, v31
    s_or_b32 s60, s2, s36
    s_cbranch_scc1 L_noepoch
    v_mov_b32 v34, s38
    s_mov_b64 exec, 1
    buffer_store_dword v34, off, s[12:15], 0 offset:0 sc1
    s_mov_b64 exec, -1
L_noepoch:
    v_mov_b32 v28, s53
    v_mul_f32_e64 v28, s54, v28
    v_pk_mul_f32 v[172:173], v[172:173], v[28:29] op_sel_hi:[1,0]
    v_pk_mul_f32 v[174:175], v[174:175], v[28:29] op_sel_hi:[1,0]
    v_pk_mul_f32 v[176:177], v[176:177], v[28:29] op_sel_hi:[1,0]
    v_pk_mul_f32 v[178:179], v[178:179], v[28:29] op_sel_hi:[1,0]
    v_pk_mul_f32 v[180:181], v[180:181], v[28:29] op_sel_hi:[1,0]
    v_pk_mul_f32 v[182:183], v[182:183], v[28:29] op_sel_hi:[1,0]
    v_pk_mul_f32 v[184:185], v[184:185], v[28:29] op_sel_hi:[1,0]
    v_pk_mul_f32 v[186:187], v[186:187], v[28:29] op_sel_hi:[1,0]
L_rstop_32:
    buffer_load_dwordx4 v[232:235], v11, s[12:15], s57 offen sc1
    s_sub_u32 s42, s42, 1
    s_cbranch_scc1 L_to_34
    s_waitcnt vmcnt(0)
    v_or3_b32 v32, v232, v233, v234
    v_or_b32 v32, v32, v235
    v_cmp_gt_i32 vcc, 0, v32
    s_nop 0
    s_nop 0
    s_cbranch_vccnz L_rstop_32
L_rsok_33:
    v_pk_mul_f32 v[28:29], v[232:233], v[132:133]
    v_pk_mul_f32 v[30:31], v[234:235], v[134:135]
    v_cvt_pk_f16_f32 v102, v28, v29
    v_cvt_pk_f16_f32 v103, v30, v31
    s_add_u32 s57, s57, 0x10000
    v_pk_mul_f16 v196, v120, v102 op_sel:[0,0] op_sel_hi:[1,0]
    v_pk_mul_f16 v197, v121, v102 op_sel:[0,1] op_sel_hi:[1,1]
    v_pk_mul_f16 v198, v122, v103 op_sel:[0,0] op_sel_hi:[1,0]
    v_pk_mul_f16 v199, v123, v103 op_sel:[0,1] op_sel_hi:[1,1]
    s_nop 0
    s_nop 0
    v_mfma_f32_16x16x32_f16 v[40:43], v[196:199], v[20:23], 0
    v_mfma_f32_16x16x32_f16 v[44:47], v[196:199], v[24:27], 0
    v_pk_mul_f16 v200, v124, v102 op_sel:[0,0] op_sel_hi:[1,0]
    v_pk_mul_f16 v201, v125, v102 op_sel:[0,1] op_sel_hi:[1,1]
    v_pk_mul_f16 v202, v126, v103 op_sel:[0,0] op_sel_hi:[1,0]
    v_pk_mul_f16 v203, v127, v103 op_sel:[0,1] op_sel_hi:[1,1]
    s_nop 0
    s_nop 0
    v_mfma_f32_16x16x32_f16 v[48:51], v[200:203], v[20:23], 0
    v_mfma_f32_16x16x32_f16 v[52:55], v[200:203], v[24:27], 0
    v_cvt_pk_f16_f32 v204, v40, v44
    v_cvt_pk_f16_f32 v205, v41, v45
    v_cvt_pk_f16_f32 v206, v42, v46
    v_cvt_pk_f16_f32 v207, v43, v47
    v_pk_mul_f16 v28, v204, v76 op_sel:[0,0] op_sel_hi:[1,0]
    v_pk_mul_f16 v29, v205, v77 op_sel:[0,0] op_sel_hi:[1,0]
    v_pk_mul_f16 v30, v206, v78 op_sel:[0,0] op_sel_hi:[1,0]
    v_pk_mul_f16 v31, v207, v79 op_sel:[0,0] op_sel_hi:[1,0]
    v_pk_fma_f16 v196, v204, v76, v28 op_sel:[1,1,0] op_sel_hi:[0,1,1] neg_hi:[1,0,0]
    v_pk_fma_f16 v197, v205, v77, v29 op_sel:[1,1,0] op_sel_hi:[0,1,1] neg_hi:[1,0,0]
    v_pk_fma_f16 v198, v206, v78, v30 op_sel:[1,1,0] op_sel_hi:[0,1,1] neg_hi:[1,0,0]
    v_pk_fma_f16 v199, v207, v79, v31 op_sel:[1,1,0] op_sel_hi:[0,1,1] neg_hi:[1,0,0]
    s_nop 0
    s_nop 0
    v_mfma_f32_16x16x32_f16 v[40:43], v[84:87], v[196:199], 0
    v_mfma_f32_16x16x32_f16 v[44:47], v[88:91], v[196:199], 0
    v_cvt_pk_f16_f32 v208, v48, v52
    v_cvt_pk_f16_f32 v209, v49, v53
    v_cvt_pk_f16_f32 v210, v50, v54
    v_cvt_pk_f16_f32 v211, v51, v55
    v_pk_mul_f16 v32, v208, v76 op_sel:[0,0] op_sel_hi:[1,0]
    v_pk_mul_f16 v33, v209, v77 op_sel:[0,0] op_sel_hi:[1,0]
    v_pk_mul_f16 v34, v210, v78 op_sel:[0,0] op_sel_hi:[1,0]
    v_pk_mul_f16 v35, v211, v79 op_sel:[0,0] op_sel_hi:[1,0]
    v_pk_fma_f16 v200, v208, v76, v32 op_sel:[1,1,0] op_sel_hi:[0,1,1] neg_hi:[1,0,0]
    v_pk_fma_f16 v201, v209, v77, v33 op_sel:[1,1,0] op_sel_hi:[0,1,1] neg_hi:[1,0,0]
    v_pk_fma_f16 v202, v210, v78, v34 op_sel:[1,1,0] op_sel_hi:[0,1,1] neg_hi:[1,0,0]
    v_pk_fma_f16 v203, v211, v79, v35 op_sel:[1,1,0] op_sel_hi:[0,1,1] neg_hi:[1,0,0]
    s_nop 0
    s_nop 0
    v_mfma_f32_16x16x32_f16 v[48:51], v[84:87], v[200:203], 0
    v_mfma_f32_16x16x32_f16 v[52:55], v[88:91], v[200:203], 0
    v_cvt_pk_f16_f32 v204, v40, v44
    v_cvt_pk_f16_f32 v205, v41, v45
    v_cvt_pk_f16_f32 v206, v42, v46
    v_cvt_pk_f16_f32 v207, v43, v47
    ds_write_b128 v11, v[204:207] offset:0
    s_nop 1
    s_nop 0
    v_cvt_pk_f16_f32 v208, v48, v52
    v_cvt_pk_f16_f32 v209, v49, v53
    v_cvt_pk_f16_f32 v210, v50, v54
    v_cvt_pk_f16_f32 v211, v51, v55
    ds_write_b128 v11, v[208:211] offset:8192
    s_waitcnt lgkmcnt(0)
    s_barrier
    s_nop 0
    s_setprio 2
    ds_read2st64_b32 v[196:197], v71 offset0:0 offset1:4
    ds_read2st64_b32 v[198:199], v71 offset0:8 offset1:12
    ds_read2st64_b32 v[200:201], v71 offset0:32 offset1:36
    ds_read2st64_b32 v[202:203], v71 offset0:40 offset1:44
    s_waitcnt lgkmcnt(2)
    v_mfma_f32_16x16x32_f16 v[40:43], v[152:155], v[196:199], 0
    v_mfma_f32_16x16x32_f16 v[44:47], v[156:159], v[196:199], 0
    s_waitcnt lgkmcnt(0)
    v_mfma_f32_16x16x32_f16 v[48:51], v[152:155], v[200:203], 0
    v_mfma_f32_16x16x32_f16 v[52:55], v[156:159], v[200:203], 0
    s_nop 3
    s_nop 0
    v_cvt_pk_f16_f32 v204, v40, v44
    v_cvt_pk_f16_f32 v205, v41, v45
    v_cvt_pk_f16_f32 v206, v42, v46
    v_cvt_pk_f16_f32 v207, v43, v47
    v_pk_mul_f16 v28, v204, v60 op_sel:[0,1] op_sel_hi:[0,0]
    v_pk_mul_f16 v29, v205, v61 op_sel:[0,1] op_sel_hi:[0,0]
    v_pk_mul_f16 v30, v206, v62 op_sel:[0,1] op_sel_hi:[0,0]
    v_pk_mul_f16 v31, v207, v63 op_sel:[0,1] op_sel_hi:[0,0]
    v_pk_fma_f16 v196, v204, v60, v28 op_sel:[1,0,0] op_sel_hi:[1,1,1] neg_hi:[1,0,0]
    v_pk_fma_f16 v197, v205, v61, v29 op_sel:[1,0,0] op_sel_hi:[1,1,1] neg_hi:[1,0,0]
    v_pk_fma_f16 v198, v206, v62, v30 op_sel:[1,0,0] op_sel_hi:[1,1,1] neg_hi:[1,0,0]
    v_pk_fma_f16 v199, v207, v63, v31 op_sel:[1,0,0] op_sel_hi:[1,1,1] neg_hi:[1,0,0]
    s_nop 1
    v_mfma_f32_16x16x32_f16 v[44:47], v[152:155], v[196:199], 0
    v_mfma_f32_16x16x32_f16 v[40:43], v[156:159], v[196:199], 0
    s_setprio 1
    v_cvt_pk_f16_f32 v208, v48, v52
    v_cvt_pk_f16_f32 v209, v49, v53
    v_cvt_pk_f16_f32 v210, v50, v54
    v_cvt_pk_f16_f32 v211, v51, v55
    v_pk_mul_f16 v32, v208, v64 op_sel:[0,1] op_sel_hi:[0,0]
    v_pk_mul_f16 v33, v209, v65 op_sel:[0,1] op_sel_hi:[0,0]
    v_pk_mul_f16 v34, v210, v66 op_sel:[0,1] op_sel_hi:[0,0]
    v_pk_mul_f16 v35, v211, v67 op_sel:[0,1] op_sel_hi:[0,0]
    v_pk_fma_f16 v200, v208, v64, v32 op_sel:[1,0,0] op_sel_hi:[1,1,1] neg_hi:[1,0,0]
    v_pk_fma_f16 v201, v209, v65, v33 op_sel:[1,0,0] op_sel_hi:[1,1,1] neg_hi:[1,0,0]
    v_pk_fma_f16 v202, v210, v66, v34 op_sel:[1,0,0] op_sel_hi:[1,1,1] neg_hi:[1,0,0]
    v_pk_fma_f16 v203, v211, v67, v35 op_sel:[1,0,0] op_sel_hi:[1,1,1] neg_hi:[1,0,0]
    s_nop 0
    s_nop 0
    v_mfma_f32_16x16x32_f16 v[52:55], v[152:155], v[200:203], 0
    v_mfma_f32_16x16x32_f16 v[48:51], v[156:159], v[200:203], 0
    v_cvt_pk_f16_f32 v204, v40, v44
    v_cvt_pk_f16_f32 v205, v41, v45
    ds_write2st64_b32 v71, v204, v205 offset0:0 offset1:4
    v_cvt_pk_f16_f32 v206, v42, v46
    v_cvt_pk_f16_f32 v207, v43, v47
    ds_write2st64_b32 v71, v206, v207 offset0:8 offset1:12
    s_setprio 0
    s_nop 0
    v_cvt_pk_f16_f32 v208, v48, v52
    v_cvt_pk_f16_f32 v209, v49, v53
    ds_write2st64_b32 v71, v208, v209 offset0:32 offset1:36
    v_cvt_pk_f16_f32 v210, v50, v54
    v_cvt_pk_f16_f32 v211, v51, v55
    ds_write2st64_b32 v71, v210, v211 offset0:40 offset1:44
    s_cmp_eq_u32 s80, 0
    s_cbranch_scc1 L_nohu_35
    s_add_u32 s61, s64, 2
    s_mov_b64 exec, 1
    v_mov_b32_e64 v231, s61
    buffer_store_dword v231, off, s[12:15], s80 sc1
    s_mov_b64 exec, -1
L_nohu_35:
    s_waitcnt lgkmcnt(0)
    s_barrier
    s_setprio 1
    ds_read_b128 v[196:199], v11 offset:0
    ds_read_b128 v[200:203], v11 offset:8192
    s_waitcnt lgkmcnt(1)
    v_mfma_f32_16x16x32_f16 v[40:43], v[196:199], v[92:95], 0
    v_mfma_f32_16x16x32_f16 v[44:47], v[196:199], v[96:99], 0
    s_waitcnt lgkmcnt(0)
    v_mfma_f32_16x16x32_f16 v[48:51], v[200:203], v[92:95], 0
    v_mfma_f32_16x16x32_f16 v[52:55], v[200:203], v[96:99], 0
    s_nop 3
    s_nop 0
    v_cvt_pk_f16_f32 v204, v40, v44
    v_cvt_pk_f16_f32 v205, v41, v45
    v_cvt_pk_f16_f32 v206, v42, v46
    v_cvt_pk_f16_f32 v207, v43, v47
    v_pk_mul_f16 v28, v204, v80 op_sel:[0,1] op_sel_hi:[0,0]
    v_pk_mul_f16 v29, v205, v81 op_sel:[0,1] op_sel_hi:[0,0]
    v_pk_mul_f16 v30, v206, v82 op_sel:[0,1] op_sel_hi:[0,0]
    v_pk_mul_f16 v31, v207, v83 op_sel:[0,1] op_sel_hi:[0,0]
    v_pk_fma_f16 v196, v204, v80, v28 op_sel:[1,0,0] op_sel_hi:[1,1,1] neg_hi:[1,0,0]
    v_pk_fma_f16 v197, v205, v81, v29 op_sel:[1,0,0] op_sel_hi:[1,1,1] neg_hi:[1,0,0]
    v_pk_fma_f16 v198, v206, v82, v30 op_sel:[1,0,0] op_sel_hi:[1,1,1] neg_hi:[1,0,0]
    v_pk_fma_f16 v199, v207, v83, v31 op_sel:[1,0,0] op_sel_hi:[1,1,1] neg_hi:[1,0,0]
    s_nop 0
    s_nop 0
    v_mfma_f32_16x16x32_f16 v[172:175], v[24:27], v[196:199], v[172:175]
    v_mfma_f32_16x16x32_f16 v[176:179], v[20:23], v[196:199], v[176:179]
    v_cvt_pk_f16_f32 v208, v48, v52
    v_cvt_pk_f16_f32 v209, v49, v53
    v_cvt_pk_f16_f32 v210, v50, v54
    v_cvt_pk_f16_f32 v211, v51, v55
    v_pk_mul_f16 v32, v208, v80 op_sel:[0,1] op_sel_hi:[0,0]
    v_pk_mul_f16 v33, v209, v81 op_sel:[0,1] op_sel_hi:[0,0]
    v_pk_mul_f16 v34, v210, v82 op_sel:[0,1] op_sel_hi:[0,0]
    v_pk_mul_f16 v35, v211, v83 op_sel:[0,1] op_sel_hi:[0,0]
    v_pk_fma_f16 v200, v208, v80, v32 op_sel:[1,0,0] op_sel_hi:[1,1,1] neg_hi:[1,0,0]
    v_pk_fma_f16 v201, v209, v81, v33 op_sel:[1,0,0] op_sel_hi:[1,1,1] neg_hi:[1,0,0]
    v_pk_fma_f16 v202, v210, v82, v34 op_sel:[1,0,0] op_sel_hi:[1,1,1] neg_hi:[1,0,0]
    v_pk_fma_f16 v203, v211, v83, v35 op_sel:[1,0,0] op_sel_hi:[1,1,1] neg_hi:[1,0,0]
    v_pk_mul_f32 v[132:133], v[172:173], v[172:173]
    v_pk_mul_f32 v[134:135], v[174:175], v[174:175]
    v_pk_fma_f32 v[132:133], v[176:177], v[176:177], v[132:133]
    v_pk_fma_f32 v[134:135], v[178:179], v[178:179], v[134:135]
    v_mfma_f32_16x16x32_f16 v[180:183], v[24:27], v[200:203], v[180:183]
    v_mfma_f32_16x16x32_f16 v[184:187], v[192:195], v[200:203], v[184:187]
    v_mul_f32 v228, s52, s52
    s_mov_b32 s60, 8388608
    s_nop 3
    s_nop 0
    v_pk_fma_f32 v[132:133], v[180:181], v[180:181], v[132:133]
    v_pk_fma_f32 v[134:135], v[182:183], v[182:183], v[134:135]
    v_pk_fma_f32 v[132:133], v[184:185], v[184:185], v[132:133]
    v_pk_fma_f32 v[134:135], v[186:187], v[186:187], v[134:135]
    v_pk_mul_f32 v[28:29], v[132:133], v[228:229] op_sel_hi:[1,0]
    v_pk_mul_f32 v[30:31], v[134:135], v[228:229] op_sel_hi:[1,0]
    v_cvt_pk_bf16_f32 v34, v28, v29
    v_cvt_pk_bf16_f32 v35, v30, v31
    buffer_store_dwordx2 v[34:35], v128, s[12:15], s60 offen sc1
    s_nop 0
    s_setprio 0
    v_max_f32 v132, 0x0da24260, v132
    v_max_f32 v133, 0x0da24260, v133
    v_max_f32 v134, 0x0da24260, v134
    v_max_f32 v135, 0x0da24260, v135
    v_rsq_f32 v28, v132
    v_rsq_f32 v29, v133
    v_rsq_f32 v30, v134
    v_rsq_f32 v31, v135
    v_pk_mul_f32 v[40:41], v[172:173], v[28:29]
    v_pk_mul_f32 v[42:43], v[174:175], v[30:31]
    v_pk_mul_f32 v[44:45], v[176:177], v[28:29]
    v_pk_mul_f32 v[46:47], v[178:179], v[30:31]
    v_pk_mul_f32 v[48:49], v[180:181], v[28:29]
    v_pk_mul_f32 v[50:51], v[182:183], v[30:31]
    v_pk_mul_f32 v[52:53], v[184:185], v[28:29]
    v_pk_mul_f32 v[54:55], v[186:187], v[30:31]
    v_cvt_pk_f16_f32 v120, v40, v44
    v_cvt_pk_f16_f32 v121, v41, v45
    v_cvt_pk_f16_f32 v122, v42, v46
    v_cvt_pk_f16_f32 v123, v43, v47
    v_cvt_pk_f16_f32 v124, v48, v52
    v_cvt_pk_f16_f32 v125, v49, v53
    v_cvt_pk_f16_f32 v126, v50, v54
    v_cvt_pk_f16_f32 v127, v51, v55
    v_mul_f32 v28, s52, v28
    v_mul_f32 v132, v132, v28
    v_mul_f32 v29, s52, v29
    v_mul_f32 v133, v133, v29
    v_mul_f32 v30, s52, v30
    v_mul_f32 v134, v134, v30
    v_mul_f32 v31, s52, v31
    v_mul_f32 v135, v135, v31
    v_mul_f32 v28, s54, v188
    v_mul_f32 v29, s54, v189
    v_mul_f32 v30, s54, v190
    v_mul_f32 v31, s54, v191
    v_fma_mix_f32 v172, -v112, v28, v172 op_sel_hi:[1,0,0]
    v_fma_mix_f32 v176, -v112, v28, v176 op_sel:[1,0,0] op_sel_hi:[1,0,0]
    v_fma_mix_f32 v173, -v113, v29, v173 op_sel_hi:[1,0,0]
    v_fma_mix_f32 v177, -v113, v29, v177 op_sel:[1,0,0] op_sel_hi:[1,0,0]
    v_fma_mix_f32 v174, -v114, v30, v174 op_sel_hi:[1,0,0]
    v_fma_mix_f32 v178, -v114, v30, v178 op_sel:[1,0,0] op_sel_hi:[1,0,0]
    v_fma_mix_f32 v175, -v115, v31, v175 op_sel_hi:[1,0,0]
    v_fma_mix_f32 v179, -v115, v31, v179 op_sel:[1,0,0] op_sel_hi:[1,0,0]
    v_fma_mix_f32 v180, -v116, v28, v180 op_sel_hi:[1,0,0]
    v_fma_mix_f32 v184, -v116, v28, v184 op_sel:[1,0,0] op_sel_hi:[1,0,0]
    v_fma_mix_f32 v181, -v117, v29, v181 op_sel_hi:[1,0,0]
    v_fma_mix_f32 v185, -v117, v29, v185 op_sel:[1,0,0] op_sel_hi:[1,0,0]
    v_fma_mix_f32 v182, -v118, v30, v182 op_sel_hi:[1,0,0]
    v_fma_mix_f32 v186, -v118, v30, v186 op_sel:[1,0,0] op_sel_hi:[1,0,0]
    v_fma_mix_f32 v183, -v119, v31, v183 op_sel_hi:[1,0,0]
    v_fma_mix_f32 v187, -v119, v31, v187 op_sel:[1,0,0] op_sel_hi:[1,0,0]
    s_lshr_b32 s62, s36, 1
    s_lshl2_add_u32 s60, s36, s62
    s_and_b32 s60, s60, 7
    s_lshr_b32 s60, s67, s60
    s_and_b32 s60, s60, 1
    s_lshl_b32 s60, s60, 13
    v_mov_b32 v228, s53
    v_mul_f32 v229, s59, v228
    v_mov_b32 v230, s64
    s_lshl_b32 s61, s62, 11
    s_or_b32 s60, s60, s61
    s_and_b32 s61, s2, 128
    s_lshl_b32 s61, s61, 6
    s_xor_b32 s60, s60, s61
    s_mul_i32 s61, s2, 5760
    s_and_b32 s61, s61, 7936
    s_xor_b32 s60, s60, s61
    s_lshl_b32 s61, s2, 14
    s_add_u32 s60, s60, s61
    s_add_u32 s60, s60, 16777216
    v_and_b32_e64 v28, 0x38, v4
    v_add_lshl_u32 v28, v28, v4, 4
    v_xor_b32_e64 v170, s60, v28
    v_xor_b32 v171, 128, v170
    s_sub_u32 s60, s2, 1
    s_lshl_b32 s61, s36, 8
    s_or_b32 s61, s61, s60
    s_lshl_b32 s60, s60, 7
    s_add_u32 s60, s60, 16384
    s_cmp_lt_u32 s61, 96
    s_cselect_b32 s63, s60, 0
    v_mov_b32 v28, s52
    v_mul_f32_e64 v28, s55, v28
    v_pk_mul_f32 v[172:173], v[172:173], v[28:29] op_sel_hi:[1,0]
    v_pk_mul_f32 v[174:175], v[174:175], v[28:29] op_sel_hi:[1,0]
    v_pk_mul_f32 v[176:177], v[176:177], v[28:29] op_sel_hi:[1,0]
    v_pk_mul_f32 v[178:179], v[178:179], v[28:29] op_sel_hi:[1,0]
    v_pk_mul_f32 v[180:181], v[180:181], v[28:29] op_sel_hi:[1,0]
    v_pk_mul_f32 v[182:183], v[182:183], v[28:29] op_sel_hi:[1,0]
    v_pk_mul_f32 v[184:185], v[184:185], v[28:29] op_sel_hi:[1,0]
    v_pk_mul_f32 v[186:187], v[186:187], v[28:29] op_sel_hi:[1,0]
L_rstop_36:
    buffer_load_dwordx4 v[232:235], v11, s[12:15], s57 offen sc1
    s_sub_u32 s42, s42, 1
    s_cbranch_scc1 L_to_38
    s_waitcnt vmcnt(0)
    v_or3_b32 v32, v232, v233, v234
    v_or_b32 v32, v32, v235
    v_cmp_gt_i32 vcc, 0, v32
    s_nop 0
    s_nop 0
    s_cbranch_vccnz L_rstop_36
L_rsok_37:
    v_pk_mul_f32 v[28:29], v[232:233], v[132:133]
    v_pk_mul_f32 v[30:31], v[234:235], v[134:135]
    v_cvt_pk_f16_f32 v102, v28, v29
    v_cvt_pk_f16_f32 v103, v30, v31
    s_add_u32 s57, s57, 0x10000
    v_pk_mul_f16 v196, v120, v102 op_sel:[0,0] op_sel_hi:[1,0]
    v_pk_mul_f16 v197, v121, v102 op_sel:[0,1] op_sel_hi:[1,1]
    v_pk_mul_f16 v198, v122, v103 op_sel:[0,0] op_sel_hi:[1,0]
    v_pk_mul_f16 v199, v123, v103 op_sel:[0,1] op_sel_hi:[1,1]
    s_nop 0
    s_nop 0
    v_mfma_f32_16x16x32_f16 v[40:43], v[196:199], v[20:23], 0
    v_mfma_f32_16x16x32_f16 v[44:47], v[196:199], v[24:27], 0
    v_pk_mul_f16 v200, v124, v102 op_sel:[0,0] op_sel_hi:[1,0]
    v_pk_mul_f16 v201, v125, v102 op_sel:[0,1] op_sel_hi:[1,1]
    v_pk_mul_f16 v202, v126, v103 op_sel:[0,0] op_sel_hi:[1,0]
    v_pk_mul_f16 v203, v127, v103 op_sel:[0,1] op_sel_hi:[1,1]
    s_nop 0
    s_nop 0
    v_mfma_f32_16x16x32_f16 v[48:51], v[200:203], v[20:23], 0
    v_mfma_f32_16x16x32_f16 v[52:55], v[200:203], v[24:27], 0
    v_cvt_pk_f16_f32 v204, v40, v44
    v_cvt_pk_f16_f32 v205, v41, v45
    v_cvt_pk_f16_f32 v206, v42, v46
    v_cvt_pk_f16_f32 v207, v43, v47
    v_pk_mul_f16 v28, v204, v76 op_sel:[0,0] op_sel_hi:[1,0]
    v_pk_mul_f16 v29, v205, v77 op_sel:[0,0] op_sel_hi:[1,0]
    v_pk_mul_f16 v30, v206, v78 op_sel:[0,0] op_sel_hi:[1,0]
    v_pk_mul_f16 v31, v207, v79 op_sel:[0,0] op_sel_hi:[1,0]
    v_pk_fma_f16 v196, v204, v76, v28 op_sel:[1,1,0] op_sel_hi:[0,1,1] neg_hi:[1,0,0]
    v_pk_fma_f16 v197, v205, v77, v29 op_sel:[1,1,0] op_sel_hi:[0,1,1] neg_hi:[1,0,0]
    v_pk_fma_f16 v198, v206, v78, v30 op_sel:[1,1,0] op_sel_hi:[0,1,1] neg_hi:[1,0,0]
    v_pk_fma_f16 v199, v207, v79, v31 op_sel:[1,1,0] op_sel_hi:[0,1,1] neg_hi:[1,0,0]
    s_nop 0
    s_nop 0
    v_mfma_f32_16x16x32_f16 v[40:43], v[84:87], v[196:199], 0
    v_mfma_f32_16x16x32_f16 v[44:47], v[88:91], v[196:199], 0
    v_cvt_pk_f16_f32 v208, v48, v52
    v_cvt_pk_f16_f32 v209, v49, v53
    v_cvt_pk_f16_f32 v210, v50, v54
    v_cvt_pk_f16_f32 v211, v51, v55
    v_pk_mul_f16 v32, v208, v76 op_sel:[0,0] op_sel_hi:[1,0]
    v_pk_mul_f16 v33, v209, v77 op_sel:[0,0] op_sel_hi:[1,0]
    v_pk_mul_f16 v34, v210, v78 op_sel:[0,0] op_sel_hi:[1,0]
    v_pk_mul_f16 v35, v211, v79 op_sel:[0,0] op_sel_hi:[1,0]
    v_pk_fma_f16 v200, v208, v76, v32 op_sel:[1,1,0] op_sel_hi:[0,1,1] neg_hi:[1,0,0]
    v_pk_fma_f16 v201, v209, v77, v33 op_sel:[1,1,0] op_sel_hi:[0,1,1] neg_hi:[1,0,0]
    v_pk_fma_f16 v202, v210, v78, v34 op_sel:[1,1,0] op_sel_hi:[0,1,1] neg_hi:[1,0,0]
    v_pk_fma_f16 v203, v211, v79, v35 op_sel:[1,1,0] op_sel_hi:[0,1,1] neg_hi:[1,0,0]
    s_nop 0
    s_nop 0
    v_mfma_f32_16x16x32_f16 v[48:51], v[84:87], v[200:203], 0
    v_mfma_f32_16x16x32_f16 v[52:55], v[88:91], v[200:203], 0
    v_cvt_pk_f16_f32 v204, v40, v44
    v_cvt_pk_f16_f32 v205, v41, v45
    v_cvt_pk_f16_f32 v206, v42, v46
    v_cvt_pk_f16_f32 v207, v43, v47
    ds_write_b128 v11, v[204:207] offset:0
    s_nop 1
    s_nop 0
    v_cvt_pk_f16_f32 v208, v48, v52
    v_cvt_pk_f16_f32 v209, v49, v53
    v_cvt_pk_f16_f32 v210, v50, v54
    v_cvt_pk_f16_f32 v211, v51, v55
    ds_write_b128 v11, v[208:211] offset:8192
    s_waitcnt lgkmcnt(0)
    s_barrier
    s_nop 0
    s_setprio 2
    ds_read2st64_b32 v[196:197], v71 offset0:0 offset1:4
    ds_read2st64_b32 v[198:199], v71 offset0:8 offset1:12
    ds_read2st64_b32 v[200:201], v71 offset0:32 offset1:36
    ds_read2st64_b32 v[202:203], v71 offset0:40 offset1:44
    s_waitcnt lgkmcnt(2)
    v_mfma_f32_16x16x32_f16 v[40:43], v[152:155], v[196:199], 0
    v_mfma_f32_16x16x32_f16 v[44:47], v[156:159], v[196:199], 0
    s_waitcnt lgkmcnt(0)
    v_mfma_f32_16x16x32_f16 v[48:51], v[152:155], v[200:203], 0
    v_mfma_f32_16x16x32_f16 v[52:55], v[156:159], v[200:203], 0
    s_nop 3
    s_nop 0
    v_cvt_pk_f16_f32 v204, v40, v44
    v_cvt_pk_f16_f32 v205, v41, v45
    v_cvt_pk_f16_f32 v206, v42, v46
    v_cvt_pk_f16_f32 v207, v43, v47
    v_pk_mul_f16 v28, v204, v104 op_sel:[0,1] op_sel_hi:[0,0]
    v_pk_mul_f16 v29, v205, v105 op_sel:[0,1] op_sel_hi:[0,0]
    v_pk_mul_f16 v30, v206, v106 op_sel:[0,1] op_sel_hi:[0,0]
    v_pk_mul_f16 v31, v207, v107 op_sel:[0,1] op_sel_hi:[0,0]
    v_pk_fma_f16 v196, v204, v104, v28 op_sel:[1,0,0] op_sel_hi:[1,1,1] neg_hi:[1,0,0]
    v_pk_fma_f16 v197, v205, v105, v29 op_sel:[1,0,0] op_sel_hi:[1,1,1] neg_hi:[1,0,0]
    v_pk_fma_f16 v198, v206, v106, v30 op_sel:[1,0,0] op_sel_hi:[1,1,1] neg_hi:[1,0,0]
    v_pk_fma_f16 v199, v207, v107, v31 op_sel:[1,0,0] op_sel_hi:[1,1,1] neg_hi:[1,0,0]
    s_nop 1
    v_mfma_f32_16x16x32_f16 v[44:47], v[152:155], v[196:199], 0
    v_mfma_f32_16x16x32_f16 v[40:43], v[156:159], v[196:199], 0
    s_setprio 1
    v_cvt_pk_f16_f32 v208, v48, v52
    v_cvt_pk_f16_f32 v209, v49, v53
    v_cvt_pk_f16_f32 v210, v50, v54
    v_cvt_pk_f16_f32 v211, v51, v55
    v_pk_mul_f16 v32, v208, v108 op_sel:[0,1] op_sel_hi:[0,0]
    v_pk_mul_f16 v33, v209, v109 op_sel:[0,1] op_sel_hi:[0,0]
    v_pk_mul_f16 v34, v210, v110 op_sel:[0,1] op_sel_hi:[0,0]
    v_pk_mul_f16 v35, v211, v111 op_sel:[0,1] op_sel_hi:[0,0]
    v_pk_fma_f16 v200, v208, v108, v32 op_sel:[1,0,0] op_sel_hi:[1,1,1] neg_hi:[1,0,0]
    v_pk_fma_f16 v201, v209, v109, v33 op_sel:[1,0,0] op_sel_hi:[1,1,1] neg_hi:[1,0,0]
    v_pk_fma_f16 v202, v210, v110, v34 op_sel:[1,0,0] op_sel_hi:[1,1,1] neg_hi:[1,0,0]
    v_pk_fma_f16 v203, v211, v111, v35 op_sel:[1,0,0] op_sel_hi:[1,1,1] neg_hi:[1,0,0]
    s_nop 0
    s_nop 0
    v_mfma_f32_16x16x32_f16 v[52:55], v[152:155], v[200:203], 0
    v_mfma_f32_16x16x32_f16 v[48:51], v[156:159], v[200:203], 0
    v_cvt_pk_f16_f32 v204, v40, v44
    v_cvt_pk_f16_f32 v205, v41, v45
    ds_write2st64_b32 v71, v204, v205 offset0:0 offset1:4
    v_cvt_pk_f16_f32 v206, v42, v46
    v_cvt_pk_f16_f32 v207, v43, v47
    ds_write2st64_b32 v71, v206, v207 offset0:8 offset1:12
    s_setprio 0
    s_nop 0
    v_cvt_pk_f16_f32 v208, v48, v52
    v_cvt_pk_f16_f32 v209, v49, v53
    ds_write2st64_b32 v71, v208, v209 offset0:32 offset1:36
    v_cvt_pk_f16_f32 v210, v50, v54
    v_cvt_pk_f16_f32 v211, v51, v55
    ds_write2st64_b32 v71, v210, v211 offset0:40 offset1:44
    s_waitcnt lgkmcnt(0)
    s_barrier
    s_setprio 1
    ds_read_b128 v[196:199], v11 offset:0
    ds_read_b128 v[200:203], v11 offset:8192
    s_waitcnt lgkmcnt(1)
    v_mfma_f32_16x16x32_f16 v[40:43], v[196:199], v[92:95], 0
    v_mfma_f32_16x16x32_f16 v[44:47], v[196:199], v[96:99], 0
    s_waitcnt lgkmcnt(0)
    v_mfma_f32_16x16x32_f16 v[48:51], v[200:203], v[92:95], 0
    v_mfma_f32_16x16x32_f16 v[52:55], v[200:203], v[96:99], 0
    s_nop 4
    v_cvt_pk_f16_f32 v204, v40, v44
    v_cvt_pk_f16_f32 v205, v41, v45
    v_cvt_pk_f16_f32 v206, v42, v46
    v_cvt_pk_f16_f32 v207, v43, v47
    v_pk_mul_f16 v28, v204, v80 op_sel:[0,1] op_sel_hi:[0,0]
    v_pk_mul_f16 v29, v205, v81 op_sel:[0,1] op_sel_hi:[0,0]
    v_pk_mul_f16 v30, v206, v82 op_sel:[0,1] op_sel_hi:[0,0]
    v_pk_mul_f16 v31, v207, v83 op_sel:[0,1] op_sel_hi:[0,0]
    v_pk_fma_f16 v196, v204, v80, v28 op_sel:[1,0,0] op_sel_hi:[1,1,1] neg_hi:[1,0,0]
    v_pk_fma_f16 v197, v205, v81, v29 op_sel:[1,0,0] op_sel_hi:[1,1,1] neg_hi:[1,0,0]
    v_pk_fma_f16 v198, v206, v82, v30 op_sel:[1,0,0] op_sel_hi:[1,1,1] neg_hi:[1,0,0]
    v_pk_fma_f16 v199, v207, v83, v31 op_sel:[1,0,0] op_sel_hi:[1,1,1] neg_hi:[1,0,0]
    s_nop 0
    s_nop 0
    v_mfma_f32_16x16x32_f16 v[172:175], v[24:27], v[196:199], v[172:175]
    v_mfma_f32_16x16x32_f16 v[176:179], v[20:23], v[196:199], v[176:179]
    v_cvt_pk_f16_f32 v208, v48, v52
    v_cvt_pk_f16_f32 v209, v49, v53
    v_cvt_pk_f16_f32 v210, v50, v54
    v_cvt_pk_f16_f32 v211, v51, v55
    v_pk_mul_f16 v32, v208, v80 op_sel:[0,1] op_sel_hi:[0,0]
    v_pk_mul_f16 v33, v209, v81 op_sel:[0,1] op_sel_hi:[0,0]
    v_pk_mul_f16 v34, v210, v82 op_sel:[0,1] op_sel_hi:[0,0]
    v_pk_mul_f16 v35, v211, v83 op_sel:[0,1] op_sel_hi:[0,0]
    v_pk_fma_f16 v200, v208, v80, v32 op_sel:[1,0,0] op_sel_hi:[1,1,1] neg_hi:[1,0,0]
    v_pk_fma_f16 v201, v209, v81, v33 op_sel:[1,0,0] op_sel_hi:[1,1,1] neg_hi:[1,0,0]
    v_pk_fma_f16 v202, v210, v82, v34 op_sel:[1,0,0] op_sel_hi:[1,1,1] neg_hi:[1,0,0]
    v_pk_fma_f16 v203, v211, v83, v35 op_sel:[1,0,0] op_sel_hi:[1,1,1] neg_hi:[1,0,0]
    s_nop 1
    v_mfma_f32_16x16x32_f16 v[180:183], v[24:27], v[200:203], v[180:183]
    v_mfma_f32_16x16x32_f16 v[184:187], v[192:195], v[200:203], v[184:187]
    s_cmp_eq_u32 s63, 0
    s_cbranch_scc1 L_notrig
    s_mov_b64 exec, 1
    buffer_store_dword v230, off, s[12:15], s63 sc1
    s_nop 0
    s_mov_b64 exec, -1
L_notrig:
    v_pk_mul_f32 v[172:173], v[172:173], v[228:229] op_sel:[0,0] op_sel_hi:[1,0]
    v_pk_mul_f32 v[174:175], v[174:175], v[228:229] op_sel:[0,0] op_sel_hi:[1,0]
    v_pk_mul_f32 v[176:177], v[176:177], v[228:229] op_sel:[0,0] op_sel_hi:[1,0]
    v_pk_mul_f32 v[178:179], v[178:179], v[228:229] op_sel:[0,0] op_sel_hi:[1,0]
    v_cvt_pk_bf16_f32 v120, v172, v176
    v_cvt_pk_bf16_f32 v121, v173, v177
    v_cvt_pk_bf16_f32 v122, v174, v178
    v_cvt_pk_bf16_f32 v123, v175, v179
    v_mov_b32 v220, v120
    v_mov_b32 v221, v121
    v_mov_b32 v222, v122
    v_mov_b32 v223, v123
    v_pk_mul_f32 v[180:181], v[180:181], v[228:229] op_sel:[0,1] op_sel_hi:[1,1]
    v_pk_mul_f32 v[182:183], v[182:183], v[228:229] op_sel:[0,1] op_sel_hi:[1,1]
    v_pk_mul_f32 v[184:185], v[184:185], v[228:229] op_sel:[0,1] op_sel_hi:[1,1]
    v_pk_mul_f32 v[186:187], v[186:187], v[228:229] op_sel:[0,1] op_sel_hi:[1,1]
    v_cvt_pk_bf16_f32 v124, v180, v184
    v_cvt_pk_bf16_f32 v125, v181, v185
    v_cvt_pk_bf16_f32 v126, v182, v186
    v_cvt_pk_bf16_f32 v127, v183, v187
    v_mov_b32_dpp v120, v124 row_shr:4 row_mask:0xf bank_mask:0xa
    v_mov_b32_dpp v121, v125 row_shr:4 row_mask:0xf bank_mask:0xa
    v_mov_b32_dpp v122, v126 row_shr:4 row_mask:0xf bank_mask:0xa
    v_mov_b32_dpp v123, v127 row_shr:4 row_mask:0xf bank_mask:0xa
    buffer_store_dwordx4 v[120:123], v170, s[12:15], 0 offen sc1
    v_mov_b32_dpp v124, v220 row_shl:4 row_mask:0xf bank_mask:0x5
    v_mov_b32_dpp v125, v221 row_shl:4 row_mask:0xf bank_mask:0x5
    v_mov_b32_dpp v126, v222 row_shl:4 row_mask:0xf bank_mask:0x5
    v_mov_b32_dpp v127, v223 row_shl:4 row_mask:0xf bank_mask:0x5
    buffer_store_dwordx4 v[124:127], v171, s[12:15], 0 offen sc1
    s_nop 0
    s_setprio 0
    ds_read_b128 v[60:63], v6 offset:12288
    ds_read_b128 v[64:67], v6 offset:13312
    ds_read_b128 v[68:71], v6 offset:14336
    ds_read_b128 v[72:75], v6 offset:15360
    ds_read_b128 v[76:79], v6 offset:16384
    ds_read_b128 v[80:83], v6 offset:17408
    ds_read_b128 v[84:87], v6 offset:18432
    ds_read_b128 v[88:91], v6 offset:19456
    ds_read_b128 v[104:107], v6 offset:20480
    ds_read_b128 v[108:111], v6 offset:21504
    ds_read_b128 v[112:115], v6 offset:22528
    ds_read_b128 v[116:119], v6 offset:23552
    ds_read_b128 v[92:95], v6 offset:10240
    ds_read_b128 v[96:99], v6 offset:11264
    v_mov_b32 v128, 0
    v_mov_b32 v129, 0
    v_mov_b32 v130, 0
    v_mov_b32 v131, 0
    v_mov_b32 v132, 0
    v_mov_b32 v133, 0
    v_mov_b32 v134, 0
    v_mov_b32 v135, 0
    v_mov_b32 v139, 0
    v_mov_b32 v143, 0
    v_lshlrev_b32_e64 v144, 16, v12
    v_and_b32 v152, 0xffff0000, v12
    v_lshlrev_b32_e64 v145, 16, v13
    v_and_b32 v153, 0xffff0000, v13
    v_lshlrev_b32_e64 v146, 16, v14
    v_and_b32 v154, 0xffff0000, v14
    v_lshlrev_b32_e64 v147, 16, v15
    v_and_b32 v155, 0xffff0000, v15
    v_lshlrev_b32_e64 v148, 16, v16
    v_and_b32 v156, 0xffff0000, v16
    v_mov_b32 v149, 0
    v_mov_b32 v150, 0
    v_mov_b32 v151, 0
    v_mov_b32 v157, 0
    v_mov_b32 v158, 0
    v_mov_b32 v159, 0
    s_waitcnt vmcnt(1)
    s_barrier
L_final:
    buffer_load_dwordx4 v[20:23], v100, s[12:15], 0 offen sc1
    s_mov_b64 exec, 0xffff
    buffer_load_dwordx4 v[24:27], v101, s[12:15], 0 offen sc1
    s_mov_b64 exec, -1
    s_waitcnt vmcnt(1) lgkmcnt(0)
L_t2top_39:
    ds_write2st64_b32 v9, v20, v21 offset0:0 offset1:6
    ds_write2st64_b32 v9, v22, v23 offset0:12 offset1:18
    v_max3_u32 v28, v20, v21, v22
    s_mov_b64 exec, 0xffff
    s_nop 0
    s_waitcnt vmcnt(0)
    ds_write2st64_b32 v10, v24, v25 offset0:0 offset1:6
    ds_write2st64_b32 v10, v26, v27 offset0:12 offset1:18
    v_max3_u32 v28, v24, v25, v28
    v_max3_u32 v28, v26, v27, v28
    s_mov_b64 exec, -1
    v_max_u32 v28, v28, v23
    v_cmp_eq_u32 vcc, -1, v28
    s_nop 0
    s_cbranch_vccnz L_retry_41
L_t2ok_40:
    s_mov_b32 exec_lo, 0x37763776
    s_mov_b32 exec_hi, 0x37763776
    s_waitcnt lgkmcnt(0)
    s_nop 0
    s_barrier
    ds_read2_b32 v[128:129], v57 offset0:0 offset1:20
    ds_read2_b32 v[130:131], v57 offset0:40 offset1:60
    s_mov_b32 exec_lo, 0x17771777
    s_mov_b32 exec_hi, 0x17771777
    ds_read2_b32 v[132:133], v58 offset0:60 offset1:40
    ds_read2_b32 v[134:135], v58 offset0:20 offset1:0
    s_mov_b64 exec, -1
    s_waitcnt lgkmcnt(2)
    v_mfma_f32_16x16x32_bf16 v[40:43], v[128:131], v[60:63], 0
    v_mfma_f32_16x16x32_bf16 v[44:47], v[128:131], v[64:67], 0
    s_nop 0
    s_waitcnt lgkmcnt(0)
    v_mfma_f32_16x16x32_bf16 v[40:43], v[132:135], v[68:71], v[40:43]
    v_mfma_f32_16x16x32_bf16 v[44:47], v[132:135], v[72:75], v[44:47]
    v_mfma_f32_16x16x32_bf16 v[48:51], v[128:131], v[76:79], 0
    v_mfma_f32_16x16x32_bf16 v[52:55], v[128:131], v[80:83], 0
    v_mfma_f32_16x16x32_bf16 v[48:51], v[132:135], v[84:87], v[48:51]
    v_mfma_f32_16x16x32_bf16 v[52:55], v[132:135], v[88:91], v[52:55]
    s_nop 2
    v_mul_f32 v28, v40, v104
    v_mul_f32 v32, v40, v108
    v_mul_f32 v29, v41, v105
    v_mul_f32 v33, v41, v109
    v_mul_f32 v30, v42, v106
    v_mul_f32_e64 v34, v42, v110
    v_fma_f32 v28, -v44, v108, v28
    v_fmac_f32_e64 v32, v44, v104
    v_fma_f32 v29, -v45, v109, v29
    v_fmac_f32_e64 v33, v45, v105
    v_fma_f32 v30, -v46, v110, v30
    v_fmac_f32_e64 v34, v46, v106
    v_cvt_pk_bf16_f32 v136, v28, v32
    v_cvt_pk_bf16_f32 v137, v29, v33
    v_cvt_pk_bf16_f32 v138, v30, v34
    s_nop 1
    v_mfma_f32_16x16x32_bf16 v[144:147], v[92:95], v[136:139], v[144:147]
    v_mfma_f32_16x16x32_bf16 v[148:151], v[96:99], v[136:139], v[148:151]
    v_mul_f32 v28, v48, v112
    v_mul_f32 v32, v48, v116
    v_mul_f32 v29, v49, v113
    v_mul_f32 v33, v49, v117
    v_mul_f32 v30, v50, v114
    v_mul_f32_e64 v34, v50, v118
    v_fma_f32 v28, -v52, v116, v28
    v_fmac_f32_e64 v32, v52, v112
    v_fma_f32 v29, -v53, v117, v29
    v_fmac_f32_e64 v33, v53, v113
    v_fma_f32 v30, -v54, v118, v30
    v_fmac_f32_e64 v34, v54, v114
    v_cvt_pk_bf16_f32 v140, v28, v32
    v_cvt_pk_bf16_f32 v141, v29, v33
    v_cvt_pk_bf16_f32 v142, v30, v34
    s_nop 1
    v_mfma_f32_16x16x32_bf16 v[152:155], v[92:95], v[140:143], v[152:155]
    v_mfma_f32_16x16x32_bf16 v[156:159], v[96:99], v[140:143], v[156:159]
    s_nop 6
    v_cvt_pk_bf16_f32 v28, v144, v152
    buffer_store_dword v28, v5, s[8:11], s39 offen offset:0 sc1
    v_cvt_pk_bf16_f32 v29, v145, v153
    buffer_store_dword v29, v5, s[8:11], s39 offen offset:256 sc1
    v_cvt_pk_bf16_f32 v30, v146, v154
    buffer_store_dword v30, v5, s[8:11], s39 offen offset:512 sc1
    v_cvt_pk_bf16_f32 v31, v147, v155
    buffer_store_dword v31, v5, s[8:11], s39 offen offset:768 sc1
    v_cvt_pk_bf16_f32 v32, v148, v156
    buffer_store_dword v32, v5, s[8:11], s39 offen offset:1024 sc1
L_end:
    s_endpgm
L_r1prep:
    s_cmp_ge_u32 s36, 4
    s_cbranch_scc1 L_r1_rb
    s_and_b32 s61, s36, 1
    v_cvt_f32_u32 v17, s61
    v_fmac_f32 v17, 2.0, v7
    s_cmp_ge_u32 s36, 2
    s_cbranch_scc1 L_r1_tw
    s_mul_i32 s61, s61, s48
    v_mul_f32 v19, 0x3d000000, v17
    v_mul_f32 v18, v8, v19
    v_mul_f32 v18, 4.0, v18
    v_mov_b32 v32, v18
    v_fma_f32 v33, 1.0, v19, v18
    v_fma_f32 v34, 2.0, v19, v18
    v_fmamk_f32 v35, v19, 0x40400000, v18
    v_cos_f32 v28, v32
    v_cos_f32 v29, v33
    v_cos_f32 v30, v34
    v_cos_f32 v31, v35
    v_sin_f32 v32, v32
    v_sin_f32 v33, v33
    v_sin_f32 v34, v34
    v_sin_f32 v35, v35
    v_cvt_pk_bf16_f32 v40, v28, -v32
    v_cvt_pk_bf16_f32 v44, v32, v28
    v_cvt_pk_bf16_f32 v48, v28, v32
    v_cvt_pk_bf16_f32 v52, v32, -v28
    v_cvt_pk_bf16_f32 v41, v29, -v33
    v_cvt_pk_bf16_f32 v45, v33, v29
    v_cvt_pk_bf16_f32 v49, v29, v33
    v_cvt_pk_bf16_f32 v53, v33, -v29
    v_cvt_pk_bf16_f32 v42, v30, -v34
    v_cvt_pk_bf16_f32 v46, v34, v30
    v_cvt_pk_bf16_f32 v50, v30, v34
    v_cvt_pk_bf16_f32 v54, v34, -v30
    v_cvt_pk_bf16_f32 v43, v31, -v35
    v_cvt_pk_bf16_f32 v47, v35, v31
    v_cvt_pk_bf16_f32 v51, v31, v35
    v_cvt_pk_bf16_f32 v55, v35, -v31
    v_xor_b32 v48, s61, v48
    v_xor_b32 v49, s61, v49
    v_xor_b32 v50, s61, v50
    v_xor_b32 v51, s61, v51
    v_xor_b32 v52, s61, v52
    v_xor_b32 v53, s61, v53
    v_xor_b32 v54, s61, v54
    v_xor_b32 v55, s61, v55
    s_mul_i32 s60, s36, 4096
    v_add_u32_e64 v28, s60, v6
    ds_write_b128 v28, v[40:43] offset:12288
    ds_write_b128 v28, v[44:47] offset:13312
    ds_write_b128 v28, v[48:51] offset:14336
    ds_write_b128 v28, v[52:55] offset:15360
    s_branch L_r1_addr
L_r1_tw:
    v_mul_f32 v19, 0x3acccccd, v17
    v_mul_f32 v18, v8, v19
    v_mul_f32 v18, 0x40400000, v18
    v_mov_b32_e64 v32, v18
    v_fma_f32 v33, 1.0, v19, v18
    v_fma_f32 v34, 2.0, v19, v18
    v_cos_f32 v28, v32
    v_cos_f32 v29, v33
    v_cos_f32 v30, v34
    v_sin_f32 v32, v32
    v_sin_f32 v33, v33
    v_sin_f32 v34, v34
    v_mul_f32 v40, 0x3dcccccd, v28
    v_mul_f32 v44, 0x3dcccccd, v32
    v_mul_f32 v41, 0x3dcccccd, v29
    v_mul_f32 v45, 0x3dcccccd, v33
    v_mul_f32 v42, 0x3dcccccd, v30
    v_mul_f32 v46, 0x3dcccccd, v34
    s_mul_i32 s60, s36, 2048
    v_add_u32_e64 v28, s60, v6
    ds_write_b128 v28, v[40:43] offset:16384
    ds_write_b128 v28, v[44:47] offset:17408
    s_branch L_r1_addr
L_r1_rb:
    s_cmp_lt_u32 s36, 6
    s_cbranch_scc1 L_r1_addr
    s_cmp_eq_u32 s36, 6
    s_cselect_b32 s60, 3, 0
    s_cselect_b32 s61, 0, 16
    v_bfe_u32 v28, v4, 2, 2
    v_and_b32_e64 v29, s60, v4
    v_lshl_add_u32 v28, v29, 2, v28
    v_add_u32 v28, s61, v28
    v_cvt_f32_u32 v19, v28
    v_mul_f32 v19, 0x3d4ccccd, v19
    v_mul_f32_e64 v18, v8, v19
    v_mul_f32 v18, 0x40400000, v18
    v_mov_b32_e64 v32, v18
    v_fma_f32 v33, 1.0, v19, v18
    v_fma_f32 v34, 2.0, v19, v18
    v_cos_f32 v28, v32
    v_cos_f32 v29, v33
    v_cos_f32 v30, v34
    v_sin_f32 v32, v32
    v_sin_f32 v33, v33
    v_sin_f32 v34, v34
    v_cvt_pk_bf16_f32 v40, v28, -v32
    v_cvt_pk_bf16_f32 v41, v29, -v33
    v_cvt_pk_bf16_f32 v42, v30, -v34
    v_mov_b32_e64 v43, 0
    s_mul_i32 s60, s36, 1024
    v_add_u32_e64 v28, s60, v6
    ds_write_b128 v28, v[40:43] offset:4096
L_r1_addr:
    v_and_b32 v30, 15, v4
    v_lshrrev_b32 v29, 2, v30
    v_sub_u32 v30, v30, v29
    v_lshrrev_b32 v29, 4, v4
    v_mul_u32_u24 v29, 80, v29
    v_add_lshl_u32 v30, v30, v29, 2
    s_mul_i32 s60, s36, 1536
    s_lshr_b32 s61, s36, 2
    s_lshl_b32 s61, s61, 6
    s_add_u32 s60, s60, s61
    s_add_u32 s60, s60, 16384
    v_add_u32 v57, s60, v30
    s_add_u32 s60, s60, 1040
    v_sub_u32 v58, s60, v30
    v_lshrrev_b32 v30, 2, v4
    v_and_b32 v29, 1, v4
    v_lshlrev_b32 v29, 6, v29
    v_lshl_add_u32 v30, v30, 14, v29
    v_and_b32_e64 v29, 2, v4
    v_lshl_add_u32 v30, v29, 3, v30
    s_mul_i32 s60, s36, 327680
    s_and_b32 s61, s2, 3
    s_lshl_b32 s61, s61, 11
    s_add_u32 s60, s60, s61
    s_lshr_b32 s61, s2, 4
    s_lshl_b32 s61, s61, 7
    s_add_u32 s60, s60, s61
    s_and_b32 s61, s37, 1
    s_lshl_b32 s61, s61, 5
    s_add_u32 s60, s60, s61
    s_add_u32 s60, s60, 16777216
    s_add_u32 s60, s60, s68
    s_movk_i32 s61, 0x2000
    v_add_u32 v100, s60, v30
    v_add_u32 v101, 262144, v100
    v_lshrrev_b32 v29, 8, v100
    v_lshrrev_b32 v30, 8, v101
    v_bitop3_b32 v100, v100, v29, s61 bitop3:0x78
    v_bitop3_b32 v101, v101, v30, s61 bitop3:0x78
    s_nop 0
    s_movk_i32 s61, 7936
    v_bfe_u32 v29, v100, 14, 8
    v_mul_u32_u24 v29, 5760, v29
    v_add_u32 v30, 92160, v29
    v_bitop3_b32 v100, v100, v29, s61 bitop3:0x78
    v_bitop3_b32 v101, v101, v30, s61 bitop3:0x78
    s_waitcnt lgkmcnt(0)
    s_setpc_b64 s[78:79]
L_noncolumn:
    s_cmp_ge_u32 s2, 192
    s_cselect_b32 s43, 4, s36
    s_lshr_b32 s43, s43, 2
    v_mov_b32 v124, 0
    v_mov_b32 v128, 0
    s_nop 0
    s_waitcnt vmcnt(4)
    v_perm_b32 v144, v72, v68, s46
    v_perm_b32 v145, v72, v68, s47
    v_perm_b32 v146, v73, v69, s46
    v_perm_b32 v147, v73, v69, s47
    v_perm_b32 v148, v74, v70, s46
    v_perm_b32 v149, v74, v70, s47
    s_mov_b32 exec_hi, 0x3fffff
    ds_write_b64 v59, v[144:145] offset:41472
    ds_write_b64 v59, v[146:147] offset:41480
    ds_write_b64 v59, v[148:149] offset:41488
    s_mov_b32 exec_hi, -1
    s_cmp_eq_u32 s43, 0
    s_cbranch_scc0 L_nored_43
    s_sub_u32 s61, s2, 160
    s_lshl_b32 s62, s61, 8
    s_add_u32 s57, s62, 131072
    s_lshr_b32 s60, s61, 3
    s_lshl_b32 s60, s60, 1
    s_bfe_u32 s62, s61, 0x10001
    s_or_b32 s60, s60, s62
    s_lshl_b32 s60, s60, 2
    s_add_u32 s60, s60, s36
    s_mul_i32 s60, s60, 5
    s_xor_b32 s62, s61, s77
    s_and_b32 s62, s62, 1
    s_lshl_b32 s62, s62, 14
    s_add_u32 s62, s62, s68
    s_add_u32 s62, s62, 4194304
    s_and_b32 s61, s60, 0xf8
    s_mul_i32 s61, s61, 3
    s_add_u32 s61, s61, s60
    s_lshr_b32 s63, s60, 7
    s_lshl_b32 s63, s63, 4
    s_or_b32 s61, s61, s63
    s_lshl_b32 s61, s61, 10
    s_xor_b32 s72, s61, s62
    s_add_u32 s60, s60, 1
    s_and_b32 s61, s60, 0xf8
    s_mul_i32 s61, s61, 3
    s_add_u32 s61, s61, s60
    s_lshr_b32 s63, s60, 7
    s_lshl_b32 s63, s63, 4
    s_or_b32 s61, s61, s63
    s_lshl_b32 s61, s61, 10
    s_xor_b32 s73, s61, s62
    s_add_u32 s60, s60, 1
    s_and_b32 s61, s60, 0xf8
    s_mul_i32 s61, s61, 3
    s_add_u32 s61, s61, s60
    s_lshr_b32 s63, s60, 7
    s_lshl_b32 s63, s63, 4
    s_or_b32 s61, s61, s63
    s_lshl_b32 s61, s61, 10
    s_xor_b32 s74, s61, s62
    s_add_u32 s60, s60, 1
    s_and_b32 s61, s60, 0xf8
    s_mul_i32 s61, s61, 3
    s_add_u32 s61, s61, s60
    s_lshr_b32 s63, s60, 7
    s_lshl_b32 s63, s63, 4
    s_or_b32 s61, s61, s63
    s_lshl_b32 s61, s61, 10
    s_xor_b32 s75, s61, s62
    s_add_u32 s60, s60, 1
    s_and_b32 s61, s60, 0xf8
    s_mul_i32 s61, s61, 3
    s_add_u32 s61, s61, s60
    s_lshr_b32 s63, s60, 7
    s_lshl_b32 s63, s63, 4
    s_or_b32 s61, s61, s63
    s_lshl_b32 s61, s61, 10
    s_xor_b32 s76, s61, s62
    s_add_u32 s60, s60, 1
    s_add_u32 s58, s57, 16384
    s_add_u32 s59, s57, 32768
    s_add_u32 s70, s57, 49152
    v_lshlrev_b32 v124, 4, v4
    v_lshrrev_b32 v28, 5, v4
    v_and_b32 v29, 31, v4
    v_lshlrev_b32 v29, 3, v29
    v_lshl_add_u32 v128, v28, 13, v29
    s_add_u32 s60, s72, 0
    buffer_store_dwordx4 v[36:39], v124, s[12:15], s60 offen sc1
    s_add_u32 s60, s73, 0
    buffer_store_dwordx4 v[36:39], v124, s[12:15], s60 offen sc1
    s_add_u32 s60, s74, 0
    buffer_store_dwordx4 v[36:39], v124, s[12:15], s60 offen sc1
    s_add_u32 s60, s75, 0
    buffer_store_dwordx4 v[36:39], v124, s[12:15], s60 offen sc1
    s_add_u32 s60, s76, 0
    buffer_store_dwordx4 v[36:39], v124, s[12:15], s60 offen sc1
    s_sub_u32 s62, s2, 160
    s_and_b32 s60, s62, 7
    s_lshr_b32 s60, s67, s60
    s_and_b32 s60, s60, 1
    s_lshl_b32 s60, s60, 13
    s_xor_b32 s61, s62, s77
    s_and_b32 s61, s61, 1
    s_lshl_b32 s61, s61, 14
    s_add_u32 s60, s60, s61
    s_and_b32 s61, s62, 24
    s_lshl_b32 s61, s61, 8
    s_add_u32 s60, s60, s61
    s_and_b32 s61, s62, 2
    s_lshl_b32 s61, s61, 9
    s_add_u32 s60, s60, s61
    s_add_u32 s80, s60, 327680
    s_cmp_lg_u32 s36, 0
    s_nop 0
    s_cbranch_scc1 L_nowarm
    buffer_store_dwordx4 v[36:39], v124, s[12:15], s80 offen sc1
    buffer_store_dwordx2 v[36:37], v128, s[12:15], s57 offen sc1
    buffer_store_dwordx2 v[36:37], v128, s[12:15], s58 offen sc1
    buffer_store_dwordx2 v[36:37], v128, s[12:15], s59 offen sc1
    buffer_store_dwordx2 v[36:37], v128, s[12:15], s70 offen sc1
L_nowarm:
L_nored_43:
    s_waitcnt lgkmcnt(0)
    s_barrier
    ds_read2st64_b32 v[160:161], v168 offset0:49 offset1:55
    ds_read2st64_b32 v[162:163], v168 offset0:61 offset1:67
    ds_read2st64_b32 v[164:165], v169 offset0:49 offset1:55
    ds_read2st64_b32 v[166:167], v169 offset0:61 offset1:67
    s_nop 0
    s_waitcnt lgkmcnt(0)
    v_or3_b32 v144, v160, v161, v162
    s_mov_b64 exec, 0xffff
    v_or3_b32 v144, v164, v165, v144
    v_or3_b32 v144, v166, v167, v144
    s_mov_b64 exec, -1
    v_bitop3_b32 v144, v144, v163, s45 bitop3:0xa8
    v_cmp_ne_u32 vcc, 0, v144
    s_nop 0
    s_cmp_eq_u64 vcc, 0
    s_nop 0
    s_cselect_b32 s61, 0, s45
    v_bitop3_b32 v160, v160, v140, s61 bitop3:0x76
    v_bitop3_b32 v161, v161, v141, s61 bitop3:0x76
    v_bitop3_b32 v162, v162, v142, s61 bitop3:0x76
    v_bitop3_b32 v163, v163, v143, s61 bitop3:0x76
    v_bitop3_b32 v164, v164, v140, s61 bitop3:0x76
    v_bitop3_b32 v165, v165, v141, s61 bitop3:0x76
    v_bitop3_b32 v166, v166, v142, s61 bitop3:0x76
    v_bitop3_b32 v167, v167, v143, s61 bitop3:0x76
    s_waitcnt vmcnt(0)
    s_waitcnt lgkmcnt(0)
    s_barrier
    s_cmp_eq_u32 s43, 0
    s_cbranch_scc0 L_nored_44
    s_cmp_lg_u32 s36, 0
    s_cbranch_scc1 L_noready
    s_or_b32 s60, s64, 0x80000000
    v_mov_b32 v28, s60
    v_mov_b32_e64 v29, s60
    buffer_store_dwordx2 v[28:29], v128, s[12:15], s57 offen sc1
    buffer_store_dwordx2 v[28:29], v128, s[12:15], s58 offen sc1
    buffer_store_dwordx2 v[28:29], v128, s[12:15], s59 offen sc1
    buffer_store_dwordx2 v[28:29], v128, s[12:15], s70 offen sc1
L_noready:
L_nored_44:
    s_call_b64 s[78:79], L_r1prep
    s_and_b32 s60, s2, 3
    s_lshl_b32 s60, s60, 2
    s_lshr_b32 s61, s36, 2
    s_add_u32 s60, s60, s61
    s_lshl_b32 s60, s60, 13
    s_add_u32 s60, s60, s68
    s_add_u32 s69, s60, 393216
    v_and_b32 v75, 0x1fe0, v11
    v_add_u32 v75, v75, v11
    buffer_load_dwordx4 v[188:191], v75, s[12:15], s69 offen sc1
    s_lshr_b32 s3, s64, 8
    s_lshr_b32 s41, s64, 16
    s_lshr_b32 s63, s64, 24
    s_waitcnt vmcnt(0)
L_stop_45:
    v_xor_b32_e64 v29, s64, v188
    v_bitop3_b32 v29, v189, s3, v29 bitop3:0xbe
    v_bitop3_b32 v29, v190, s41, v29 bitop3:0xbe
    v_bitop3_b32 v29, v191, s63, v29 bitop3:0xbe
    v_and_b32 v29, 0xff, v29
    v_cmp_ne_u32 vcc, 0, v29
    s_nop 0
    s_nop 0
    s_cbranch_vccnz L_retry_47
L_sok_46:
    s_mov_b32 s71, 25165824
    buffer_store_dwordx4 v[160:163], v130, s[12:15], s71 offen sc1
    s_mov_b64 exec, 0xffff
    buffer_store_dwordx4 v[164:167], v131, s[12:15], s71 offen sc1
    s_mov_b64 exec, -1
    s_cmp_ge_u32 s2, 192
    s_cbranch_scc1 L_trigger
    s_cmp_ge_u32 s36, 4
    s_cbranch_scc1 L_red_idle
    s_add_u32 s60, s72, 1048576
    buffer_store_dwordx4 v[36:39], v124, s[12:15], s60 offen sc1
    s_add_u32 s60, s73, 1048576
    buffer_store_dwordx4 v[36:39], v124, s[12:15], s60 offen sc1
    s_add_u32 s60, s74, 1048576
    buffer_store_dwordx4 v[36:39], v124, s[12:15], s60 offen sc1
    s_add_u32 s60, s75, 1048576
    buffer_store_dwordx4 v[36:39], v124, s[12:15], s60 offen sc1
    s_add_u32 s60, s76, 1048576
    buffer_store_dwordx4 v[36:39], v124, s[12:15], s60 offen sc1
    s_add_u32 s60, s72, 4194304
    buffer_store_dwordx4 v[36:39], v124, s[12:15], s60 offen sc1
    s_add_u32 s60, s73, 4194304
    buffer_store_dwordx4 v[36:39], v124, s[12:15], s60 offen sc1
    s_add_u32 s60, s74, 4194304
    buffer_store_dwordx4 v[36:39], v124, s[12:15], s60 offen sc1
    s_add_u32 s60, s75, 4194304
    buffer_store_dwordx4 v[36:39], v124, s[12:15], s60 offen sc1
    s_add_u32 s60, s76, 4194304
    buffer_store_dwordx4 v[36:39], v124, s[12:15], s60 offen sc1
    s_cmp_lg_u32 s36, 0
    s_cbranch_scc1 L_noclr
    s_add_u32 s60, s57, 65536
    buffer_store_dwordx2 v[36:37], v128, s[12:15], s60 offen sc1
    s_add_u32 s60, s58, 65536
    buffer_store_dwordx2 v[36:37], v128, s[12:15], s60 offen sc1
    s_add_u32 s60, s59, 65536
    buffer_store_dwordx2 v[36:37], v128, s[12:15], s60 offen sc1
    s_add_u32 s60, s70, 65536
    buffer_store_dwordx2 v[36:37], v128, s[12:15], s60 offen sc1
    s_add_u32 s60, s57, 131072
    buffer_store_dwordx2 v[36:37], v128, s[12:15], s60 offen sc1
    s_add_u32 s60, s58, 131072
    buffer_store_dwordx2 v[36:37], v128, s[12:15], s60 offen sc1
    s_add_u32 s60, s59, 131072
    buffer_store_dwordx2 v[36:37], v128, s[12:15], s60 offen sc1
    s_add_u32 s60, s70, 131072
    buffer_store_dwordx2 v[36:37], v128, s[12:15], s60 offen sc1
L_noclr:
    v_and_b32 v28, 1, v4
    v_lshlrev_b32 v28, 4, v28
    v_mov_b32 v29, 0x3f80
    v_lshlrev_b32_e64 v28, v28, v29
    v_bfe_u32 v29, v4, 1, 3
    v_cmp_eq_u32 s[50:51], 0, v29
    s_nop 1
    v_cndmask_b32 v60, 0, v28, s[50:51]
    v_cmp_eq_u32 s[50:51], 1, v29
    s_nop 1
    v_cndmask_b32 v61, 0, v28, s[50:51]
    v_cmp_eq_u32 s[50:51], 2, v29
    s_nop 1
    v_cndmask_b32 v62, 0, v28, s[50:51]
    v_cmp_eq_u32 s[50:51], 3, v29
    s_nop 1
    v_cndmask_b32 v63, 0, v28, s[50:51]
    s_lshl_b32 s60, s36, 9
    s_add_u32 s60, s60, 54016
    v_add_u32 v125, s60, v124
    v_bfe_u32 v28, v4, 1, 1
    v_bfe_u32 v29, v4, 2, 3
    v_lshl_add_u32 v28, v28, 4, v29
    v_and_b32_e64 v29, 1, v4
    v_lshl_add_u32 v28, v28, 1, v29
    v_lshlrev_b32_e64 v28, 3, v28
    v_add_u32 v126, 54016, v28
    v_add_u32 v127, 128, v126
    v_mov_b32 v64, 0x3ba3d70a
    v_mov_b32 v65, 0x3727c5ac
    v_mov_b32 v157, 56064
    v_mov_b32 v158, 1
L_red_layer:
    s_add_u32 s61, s64, s43
    s_lshl_b32 s62, s43, 2
    s_lshr_b32 s62, 0x881, s62
    s_and_b32 s62, s62, 15
    s_movk_i32 s63, 256
    v_lshlrev_b32 v105, 7, v4
    s_mov_b64 exec, 0xff
L_hu_poll:
    buffer_load_dword v104, v105, s[12:15], s80 offen sc1
    s_sub_u32 s63, s63, 1
    s_cselect_b32 s62, 0, s62
    s_waitcnt vmcnt(0)
    v_cmp_eq_u32 vcc, s61, v104
    s_nop 0
    s_bcnt1_i32_b64 s60, vcc
    s_cmp_lt_u32 s60, s62
    s_cbranch_scc1 L_hu_poll
    s_nop 0
    s_mov_b64 exec, -1
L_redtop_49:
    buffer_load_dwordx4 v[104:107], v124, s[12:15], s72 offen sc1
    buffer_load_dwordx4 v[108:111], v124, s[12:15], s73 offen sc1
    buffer_load_dwordx4 v[112:115], v124, s[12:15], s74 offen sc1
    buffer_load_dwordx4 v[116:119], v124, s[12:15], s75 offen sc1
    buffer_load_dwordx4 v[120:123], v124, s[12:15], s76 offen sc1
    s_sub_u32 s42, s42, 1
    s_cbranch_scc1 L_to_51
    s_waitcnt vmcnt(4)
    v_mfma_f32_16x16x32_bf16 v[152:155], v[60:63], v[104:107], 0
    s_waitcnt vmcnt(3)
    v_mfma_f32_16x16x32_bf16 v[152:155], v[60:63], v[108:111], v[152:155]
    s_waitcnt vmcnt(2)
    v_mfma_f32_16x16x32_bf16 v[152:155], v[60:63], v[112:115], v[152:155]
    s_waitcnt vmcnt(1)
    v_mfma_f32_16x16x32_bf16 v[152:155], v[60:63], v[116:119], v[152:155]
    s_waitcnt vmcnt(0)
    v_mfma_f32_16x16x32_bf16 v[152:155], v[60:63], v[120:123], v[152:155]
    s_nop 7
    v_cmp_u_f32 vcc, v152, v152
    s_nop 0
    s_cbranch_vccnz L_redtop_49
L_redok_50:
    s_mov_b32 exec_hi, 0
    ds_write_b128 v125, v[152:155]
    s_mov_b64 exec, 1
    ds_add_rtn_u32 v156, v157, v158
    s_mov_b64 exec, -1
    ds_read2st64_b64 v[104:107], v126 offset0:0 offset1:1
    ds_read2st64_b64 v[108:111], v127 offset0:0 offset1:1
    ds_read2st64_b64 v[112:115], v126 offset0:2 offset1:3
    ds_read2st64_b64 v[116:119], v127 offset0:2 offset1:3
    s_waitcnt lgkmcnt(4)
    v_readfirstlane_b32 s60, v156
    s_nop 0
    s_and_b32 s60, s60, 3
    s_cmp_lg_u32 s60, 3
    s_cbranch_scc1 L_red_next
    s_waitcnt lgkmcnt(3)
    v_pk_add_f32 v[104:105], v[104:105], v[106:107]
    s_waitcnt lgkmcnt(2)
    v_pk_add_f32 v[108:109], v[108:109], v[110:111]
    v_pk_add_f32 v[104:105], v[104:105], v[108:109]
    s_waitcnt lgkmcnt(1)
    v_pk_add_f32 v[112:113], v[112:113], v[114:115]
    v_pk_add_f32 v[104:105], v[104:105], v[112:113]
    s_waitcnt lgkmcnt(0)
    v_pk_add_f32 v[116:117], v[116:117], v[118:119]
    v_pk_add_f32 v[104:105], v[104:105], v[116:117]
    v_pk_fma_f32 v[104:105], v[104:105], v[64:65], v[64:65] op_sel:[0,0,1] op_sel_hi:[1,0,1]
    v_rsq_f32 v32, v104
    v_rsq_f32 v33, v105
    s_nop 0
    s_nop 0
    buffer_store_dwordx2 v[32:33], v128, s[12:15], s57 offen sc1
    buffer_store_dwordx2 v[32:33], v128, s[12:15], s58 offen sc1
    buffer_store_dwordx2 v[32:33], v128, s[12:15], s59 offen sc1
    buffer_store_dwordx2 v[32:33], v128, s[12:15], s70 offen sc1
L_red_next:
    s_waitcnt lgkmcnt(0)
    s_barrier
    s_lshl_b32 s60, s43, 21
    s_add_u32 s60, s60, 1048576
    v_add_u32 v124, s60, v124
    v_add_u32 v128, 0x10000, v128
    s_add_u32 s43, s43, 1
    s_cmp_lt_u32 s43, 3
    s_cbranch_scc1 L_red_layer
    s_branch L_trigger
L_red_idle:
    s_barrier
    s_barrier
    s_barrier
L_trigger:
    s_barrier
    ds_read_b128 v[60:63], v6 offset:12288
    ds_read_b128 v[64:67], v6 offset:13312
    ds_read_b128 v[68:71], v6 offset:14336
    ds_read_b128 v[72:75], v6 offset:15360
    ds_read_b128 v[76:79], v6 offset:16384
    ds_read_b128 v[80:83], v6 offset:17408
    ds_read_b128 v[84:87], v6 offset:18432
    ds_read_b128 v[88:91], v6 offset:19456
    ds_read_b128 v[104:107], v6 offset:20480
    ds_read_b128 v[108:111], v6 offset:21504
    ds_read_b128 v[112:115], v6 offset:22528
    ds_read_b128 v[116:119], v6 offset:23552
    ds_read_b128 v[92:95], v6 offset:10240
    ds_read_b128 v[96:99], v6 offset:11264
    v_mov_b32 v128, 0
    v_mov_b32 v129, 0
    v_mov_b32 v130, 0
    v_mov_b32 v131, 0
    v_mov_b32 v132, 0
    v_mov_b32 v133, 0
    v_mov_b32 v134, 0
    v_mov_b32 v135, 0
    v_mov_b32 v139, 0
    v_mov_b32 v143, 0
    v_lshlrev_b32_e64 v144, 16, v12
    v_and_b32 v152, 0xffff0000, v12
    v_lshlrev_b32_e64 v145, 16, v13
    v_and_b32 v153, 0xffff0000, v13
    v_lshlrev_b32_e64 v146, 16, v14
    v_and_b32 v154, 0xffff0000, v14
    v_lshlrev_b32_e64 v147, 16, v15
    v_and_b32 v155, 0xffff0000, v15
    v_lshlrev_b32_e64 v148, 16, v16
    v_and_b32 v156, 0xffff0000, v16
    v_mov_b32 v149, 0
    v_mov_b32 v150, 0
    v_mov_b32 v151, 0
    v_mov_b32 v157, 0
    v_mov_b32 v158, 0
    v_mov_b32 v159, 0
    s_cmp_lg_u32 s36, 0
    s_cbranch_scc1 L_trigok_53
    s_lshl_b32 s60, s2, 7
    s_add_u32 s60, s60, -4096
    s_mov_b64 exec, 1
L_trigtop_52:
    buffer_load_dword v28, off, s[12:15], s60 sc1
    s_sub_u32 s42, s42, 1
    s_cbranch_scc1 L_to_54
    s_waitcnt vmcnt(0)
    v_cmp_ne_u32 vcc, s64, v28
    s_nop 0
    s_cbranch_vccnz L_trigtop_52
L_trigok_53:
    s_mov_b64 exec, -1
    s_barrier
    s_branch L_final
L_probe:
    s_load_dwordx2 s[32:33], s[0:1], 56
    s_getreg_b32 s62, hwreg(HW_REG_XCC_ID, 0, 3)
    s_mov_b32 s14, 29360128
    s_mov_b32 s15, 0x20000
    s_cmp_lt_u32 s2, 8
    s_cselect_b32 s63, 0, 1
    s_lshr_b32 s60, s2, s63
    s_lshr_b32 s61, s62, 2
    s_xor_b32 s60, s60, s61
    s_and_b32 s60, s60, 1
    s_lshl_b32 s60, s60, 13
    s_mul_i32 s61, s2, 0x480
    s_and_b32 s61, s61, 0x1f80
    s_add_u32 s60, s60, s61
    s_lshl_b32 s61, 0x2000, s63
    s_xor_b32 s61, s61, s60
    v_lshlrev_b32 v1, 2, v0
    v_add_u32 v1, 30976, v1
    s_mov_b64 exec, 0xffff
    s_waitcnt lgkmcnt(0)
    buffer_store_dword v0, v1, s[12:15], s60 offen sc1
    buffer_store_dword v0, v1, s[12:15], s61 offen sc1
    s_barrier
    s_mov_b32 s34, 256
    s_mov_b32 s35, 0x20000
    s_mov_b64 exec, 1
    s_and_b32 s60, s2, 2
    s_and_b32 s61, s62, 1
    s_add_u32 s60, s60, s61
    s_add_u32 s60, s60, 2
    s_and_b32 s61, s2, 1
    s_cmp_eq_u32 s63, 0
    s_cselect_b32 s61, s61, s60
    s_lshl2_add_u32 s61, s61, 8
    s_cmp_eq_u32 s2, 0
    s_cselect_b32 s62, s62, 0
    s_lshl_b32 s62, s62, 5
    s_add_u32 s62, s62, 1
    s_waitcnt vmcnt(1)
    s_nop 1
    s_getreg_b32 s60, hwreg(HW_REG_IB_STS, 0, 4)
    s_lshl_b32 s60, s60, s61
    s_add_u32 s60, s60, s62
    v_mov_b32_e64 v1, s60
    buffer_atomic_add v1, off, s[32:35], 0 offset:128
    s_mov_b64 exec, -1
    s_branch L_row
L_to_4:
    s_mov_b32 s42, 0
    s_waitcnt vmcnt(0)
    v_mov_b32 v28, s2
    v_add_u32 v28, 1, v28
    buffer_store_dword v28, off, s[32:35], 0 offset:40
    s_branch L_dok_2
L_retry_3:
    s_sub_u32 s42, s42, 1
    s_cbranch_scc1 L_to_4
    buffer_load_dword v28, off, s[32:35], 0 offset:128 sc1
    s_waitcnt vmcnt(0)
    v_readfirstlane_b32 s67, v28
    s_waitcnt vmcnt(0)
    s_branch L_dtop_1
L_to_8:
    s_mov_b32 s42, 0
    s_waitcnt vmcnt(0)
    v_mov_b32 v29, s2
    v_add_u32_e64 v29, 1, v29
    buffer_store_dword v29, off, s[32:35], 0 offset:36
    s_branch L_sok_6
L_retry_7:
    s_sub_u32 s42, s42, 1
    s_cbranch_scc1 L_to_8
    s_mov_b64 exec, vcc
    buffer_load_dwordx4 v[188:191], v75, s[12:15], s69 offen sc1
    s_mov_b64 exec, -1
    s_waitcnt vmcnt(0)
    s_branch L_stop_5
L_to_12:
    s_mov_b32 s42, 0
    s_waitcnt vmcnt(0)
    v_mov_b32 v28, s2
    v_add_u32_e64 v28, 1, v28
    buffer_store_dword v28, off, s[32:35], 0 offset:8
    s_branch L_hok_10
L_retry_11:
    s_sub_u32 s42, s42, 1
    s_cbranch_scc1 L_to_12
    s_wqm_b64 exec, vcc
    s_add_u32 s60, s58, 16777216
    buffer_load_dwordx4 v[112:115], v56, s[12:15], s60 offen sc1
    buffer_load_dwordx4 v[116:119], v56, s[12:15], s60 offen offset:16 sc1
    s_waitcnt vmcnt(0)
    s_branch L_htop_9
L_nyq:
    s_nop 0
    s_movk_i32 s60, 0x39a8
    v_pk_mul_f16 v116, v116, s60
    v_pk_mul_f16 v117, v117, s60
    v_pk_mul_f16 v118, v118, s60
    v_pk_mul_f16 v119, v119, s60
    s_branch L_nyq_ret
L_wslow_15:
    v_or3_b32 v228, v220, v221, v222
    v_or_b32 v228, v228, v223
    v_bitop3_b32 v230, v220, v221, v222 bitop3:0x80
    v_bitop3_b32 v230, v230, v223, s45 bitop3:0x80
    v_or3_b32 v229, v224, v225, v226
    v_or_b32_e64 v229, v229, v227
    v_bitop3_b32 v231, v224, v225, v226 bitop3:0x80
    v_bitop3_b32 v231, v231, v227, s45 bitop3:0x80
    v_and_b32 v228, s45, v228
    v_and_b32 v229, s45, v229
    v_xor_b32 v230, s45, v230
    v_xor_b32 v231, s45, v231
    v_min_u32 v228, v228, v230
    v_min_u32 v229, v229, v231
    v_or_b32 v228, v228, v229
    v_cmp_ne_u32 vcc, 0, v228
    s_nop 0
    s_cbranch_vccz L_wgather_16
    s_sub_u32 s42, s42, 1
    s_cbranch_scc1 L_wto_17
    s_nop 0
    s_wqm_b64 exec, vcc
    s_add_u32 s60, s58, 20971520
    buffer_load_dwordx4 v[104:107], v56, s[12:15], s60 offen sc1
    buffer_load_dwordx4 v[108:111], v56, s[12:15], s60 offen offset:16 sc1
    s_mov_b64 exec, -1
    s_waitcnt vmcnt(0)
    s_branch L_wtop_13
L_wto_17:
    s_mov_b32 s42, 0
    v_mov_b32 v228, s2
    v_add_u32 v228, 1, v228
    buffer_store_dword v228, off, s[32:35], 0 offset:4
L_wgather_16:
    v_and_b32_e64 v228, 31, v4
    v_lshl_add_u32 v228, s36, 5, v228
    v_bfe_u32 v229, v228, 2, 4
    v_and_b32 v230, 0xc0, v228
    v_add_u32 v229, v229, v230
    v_and_b32 v230, 3, v228
    v_lshl_add_u32 v229, v230, 4, v229
    v_lshrrev_b32_e64 v230, 5, v4
    v_lshl_add_u32 v229, v230, 10, v229
    v_mul_u32_u24 v229, 642, v229
    s_lshl_b32 s60, s2, 2
    s_add_u32 s60, s60, 2
    buffer_load_ushort v104, v229, s[16:19], s60 offen offset:0
    buffer_load_ushort v220, v229, s[20:23], s60 offen offset:0
    buffer_load_ushort v108, v229, s[16:19], s60 offen offset:2
    buffer_load_ushort v224, v229, s[20:23], s60 offen offset:2
    s_add_u32 s60, s60, 164352
    buffer_load_ushort v105, v229, s[16:19], s60 offen offset:0
    buffer_load_ushort v221, v229, s[20:23], s60 offen offset:0
    buffer_load_ushort v109, v229, s[16:19], s60 offen offset:2
    buffer_load_ushort v225, v229, s[20:23], s60 offen offset:2
    s_add_u32 s60, s60, 164352
    buffer_load_ushort v106, v229, s[16:19], s60 offen offset:0
    buffer_load_ushort v222, v229, s[20:23], s60 offen offset:0
    buffer_load_ushort v110, v229, s[16:19], s60 offen offset:2
    buffer_load_ushort v226, v229, s[20:23], s60 offen offset:2
    s_add_u32 s60, s60, 164352
    buffer_load_ushort v107, v229, s[16:19], s60 offen offset:0
    buffer_load_ushort v223, v229, s[20:23], s60 offen offset:0
    buffer_load_ushort v111, v229, s[16:19], s60 offen offset:2
    buffer_load_ushort v227, v229, s[20:23], s60 offen offset:2
    s_add_u32 s60, s60, 164352
    s_nop 0
    s_waitcnt vmcnt(0)
    v_lshl_or_b32 v104, v220, 16, v104
    v_lshl_or_b32 v105, v221, 16, v105
    v_lshl_or_b32 v106, v222, 16, v106
    v_lshl_or_b32 v107, v223, 16, v107
    v_lshl_or_b32 v108, v224, 16, v108
    v_lshl_or_b32 v109, v225, 16, v109
    v_lshl_or_b32 v110, v226, 16, v110
    v_lshl_or_b32 v111, v227, 16, v111
    v_and_b32 v220, s49, v104
    v_and_b32 v221, s49, v105
    v_and_b32 v222, s49, v106
    v_and_b32 v223, s49, v107
    v_and_b32 v224, s49, v108
    v_and_b32 v225, s49, v109
    v_and_b32 v226, s49, v110
    v_and_b32 v227, s49, v111
    v_pk_maximum3_f16 v228, v220, v221, v222
    v_pk_maximum3_f16 v230, v223, v224, v225
    v_pk_maximum3_f16 v228, v226, v227, v228
    v_pk_max_u16 v228, v228, v230
    v_pk_max_u16 v228, v228, v228 op_sel:[0,1] op_sel_hi:[1,0]
    s_branch L_wok_14
L_to_21:
    s_mov_b32 s42, 0
    s_waitcnt vmcnt(0)
    v_mov_b32 v228, s2
    v_add_u32_e64 v228, 1, v228
    buffer_store_dword v228, off, s[32:35], 0 offset:32
    s_branch L_rok_19
L_retry_20:
    s_sub_u32 s42, s42, 1
    s_cbranch_scc1 L_to_21
    buffer_load_dwordx4 v[232:235], v11, s[12:15], s57 offen sc1
    s_waitcnt vmcnt(0)
    s_branch L_rtop_18
L_wslow_25:
    v_or3_b32 v228, v220, v221, v222
    v_or_b32 v228, v228, v223
    v_bitop3_b32 v230, v220, v221, v222 bitop3:0x80
    v_bitop3_b32 v230, v230, v223, s45 bitop3:0x80
    v_or3_b32 v229, v224, v225, v226
    v_or_b32_e64 v229, v229, v227
    v_bitop3_b32 v231, v224, v225, v226 bitop3:0x80
    v_bitop3_b32 v231, v231, v227, s45 bitop3:0x80
    v_and_b32 v228, s45, v228
    v_and_b32 v229, s45, v229
    v_xor_b32 v230, s45, v230
    v_xor_b32 v231, s45, v231
    v_min_u32 v228, v228, v230
    v_min_u32 v229, v229, v231
    v_or_b32 v228, v228, v229
    v_cmp_ne_u32 vcc, 0, v228
    s_nop 0
    s_cbranch_vccz L_wgather_26
    s_sub_u32 s42, s42, 1
    s_cbranch_scc1 L_wto_27
    s_nop 0
    s_wqm_b64 exec, vcc
    s_add_u32 s60, s58, 25165824
    buffer_load_dwordx4 v[104:107], v56, s[12:15], s60 offen sc1
    buffer_load_dwordx4 v[108:111], v56, s[12:15], s60 offen offset:16 sc1
    s_mov_b64 exec, -1
    s_waitcnt vmcnt(0)
    s_branch L_wtop_23
L_wto_27:
    s_mov_b32 s42, 0
    v_mov_b32 v228, s2
    v_add_u32 v228, 1, v228
    buffer_store_dword v228, off, s[32:35], 0 offset:12
L_wgather_26:
    v_and_b32_e64 v228, 31, v4
    v_lshl_add_u32 v228, s36, 5, v228
    v_bfe_u32 v229, v228, 2, 4
    v_and_b32 v230, 0xc0, v228
    v_add_u32 v229, v229, v230
    v_and_b32 v230, 3, v228
    v_lshl_add_u32 v229, v230, 4, v229
    v_lshrrev_b32_e64 v230, 5, v4
    v_lshl_add_u32 v229, v230, 10, v229
    v_mul_u32_u24 v229, 642, v229
    s_lshl_b32 s60, s2, 2
    s_add_u32 s60, s60, 2
    buffer_load_ushort v104, v229, s[24:27], s60 offen offset:0
    buffer_load_ushort v220, v229, s[28:31], s60 offen offset:0
    buffer_load_ushort v108, v229, s[24:27], s60 offen offset:2
    buffer_load_ushort v224, v229, s[28:31], s60 offen offset:2
    s_add_u32 s60, s60, 164352
    buffer_load_ushort v105, v229, s[24:27], s60 offen offset:0
    buffer_load_ushort v221, v229, s[28:31], s60 offen offset:0
    buffer_load_ushort v109, v229, s[24:27], s60 offen offset:2
    buffer_load_ushort v225, v229, s[28:31], s60 offen offset:2
    s_add_u32 s60, s60, 164352
    buffer_load_ushort v106, v229, s[24:27], s60 offen offset:0
    buffer_load_ushort v222, v229, s[28:31], s60 offen offset:0
    buffer_load_ushort v110, v229, s[24:27], s60 offen offset:2
    buffer_load_ushort v226, v229, s[28:31], s60 offen offset:2
    s_add_u32 s60, s60, 164352
    buffer_load_ushort v107, v229, s[24:27], s60 offen offset:0
    buffer_load_ushort v223, v229, s[28:31], s60 offen offset:0
    buffer_load_ushort v111, v229, s[24:27], s60 offen offset:2
    buffer_load_ushort v227, v229, s[28:31], s60 offen offset:2
    s_add_u32 s60, s60, 164352
    s_nop 0
    s_waitcnt vmcnt(0)
    v_lshl_or_b32 v104, v220, 16, v104
    v_lshl_or_b32 v105, v221, 16, v105
    v_lshl_or_b32 v106, v222, 16, v106
    v_lshl_or_b32 v107, v223, 16, v107
    v_lshl_or_b32 v108, v224, 16, v108
    v_lshl_or_b32 v109, v225, 16, v109
    v_lshl_or_b32 v110, v226, 16, v110
    v_lshl_or_b32 v111, v227, 16, v111
    v_and_b32 v220, s49, v104
    v_and_b32 v221, s49, v105
    v_and_b32 v222, s49, v106
    v_and_b32 v223, s49, v107
    v_and_b32 v224, s49, v108
    v_and_b32 v225, s49, v109
    v_and_b32 v226, s49, v110
    v_and_b32 v227, s49, v111
    v_pk_maximum3_f16 v228, v220, v221, v222
    v_pk_maximum3_f16 v230, v223, v224, v225
    v_pk_maximum3_f16 v228, v226, v227, v228
    v_pk_max_u16 v228, v228, v230
    v_pk_max_u16 v228, v228, v228 op_sel:[0,1] op_sel_hi:[1,0]
    s_branch L_wok_24
L_to_30:
    s_mov_b32 s42, 0
    s_waitcnt vmcnt(0)
    v_mov_b32 v32, s2
    v_add_u32_e64 v32, 1, v32
    buffer_store_dword v32, off, s[32:35], 0 offset:16
    s_branch L_rsok_29
L_to_34:
    s_mov_b32 s42, 0
    s_waitcnt vmcnt(0)
    v_mov_b32 v32, s2
    v_add_u32_e64 v32, 1, v32
    buffer_store_dword v32, off, s[32:35], 0 offset:16
    s_branch L_rsok_33
L_to_38:
    s_mov_b32 s42, 0
    s_waitcnt vmcnt(0)
    v_mov_b32 v32, s2
    v_add_u32_e64 v32, 1, v32
    buffer_store_dword v32, off, s[32:35], 0 offset:16
    s_branch L_rsok_37
L_to_42:
    s_mov_b32 s42, 0
    s_waitcnt vmcnt(0)
    v_mov_b32 v28, s2
    v_add_u32_e64 v28, 1, v28
    buffer_store_dword v28, off, s[32:35], 0 offset:20
    s_branch L_t2ok_40
L_retry_41:
    s_sub_u32 s42, s42, 1
    s_cbranch_scc1 L_to_42
    s_waitcnt lgkmcnt(0)
    buffer_load_dwordx4 v[20:23], v100, s[12:15], 0 offen sc1
    s_mov_b64 exec, 0xffff
    buffer_load_dwordx4 v[24:27], v101, s[12:15], 0 offen sc1
    s_mov_b64 exec, -1
    s_waitcnt vmcnt(0)
    s_branch L_t2top_39
L_to_48:
    s_mov_b32 s42, 0
    s_waitcnt vmcnt(0)
    v_mov_b32 v29, s2
    v_add_u32_e64 v29, 1, v29
    buffer_store_dword v29, off, s[32:35], 0 offset:44
    s_branch L_sok_46
L_retry_47:
    s_sub_u32 s42, s42, 1
    s_cbranch_scc1 L_to_48
    s_mov_b64 exec, vcc
    buffer_load_dwordx4 v[188:191], v75, s[12:15], s69 offen sc1
    s_mov_b64 exec, -1
    s_waitcnt vmcnt(0)
    s_branch L_stop_45
L_to_51:
    s_mov_b32 s42, 0
    s_waitcnt vmcnt(0)
    v_mov_b32 v28, s2
    v_add_u32_e64 v28, 1, v28
    buffer_store_dword v28, off, s[32:35], 0 offset:24
    s_branch L_redok_50
L_to_54:
    s_mov_b32 s42, 0
    s_waitcnt vmcnt(0)
    v_mov_b32 v28, s2
    v_add_u32_e64 v28, 1, v28
    buffer_store_dword v28, off, s[32:35], 0 offset:28
    s_branch L_trigok_53

.fill 1483, 4, 0xbf800000
.section .rodata,"a"
.p2align 6
.amdhsa_kernel interleave_layers__spectral_gfnet__spectral_gfnet__prompt_kernel
  .amdhsa_next_free_vgpr 256
  .amdhsa_next_free_sgpr 102
  .amdhsa_accum_offset 256
  .amdhsa_group_segment_fixed_size 0
  .amdhsa_kernarg_size 72
  .amdhsa_user_sgpr_count 2
  .amdhsa_user_sgpr_kernarg_segment_ptr 1
  .amdhsa_system_sgpr_workgroup_id_x 1
.end_amdhsa_kernel
```
